```python
import torch

def _softmax(x, axis=-1):
    return torch.softmax(x, dim=axis)
def _gelu(x):
    return torch.nn.functional.gelu(x, approximate="tanh")
def _silu(x):
    return torch.nn.functional.silu(x)
def _sigmoid(x):
    return torch.sigmoid(x)
def _layernorm(x, axis=-1, eps=1e-5):
    m = x.mean(dim=axis, keepdim=True)
    v = x.var(dim=axis, keepdim=True, unbiased=False)
    return (x - m) / torch.sqrt(v + eps)
def _scatter_add(tgt, idx, src, axis=0):
    return tgt.clone().index_add_(axis, idx, src)
def _segment_sum(src, seg, n):
    out = torch.zeros((n,) + src.shape[1:], dtype=src.dtype)
    return out.index_add_(0, seg, src)
def _pad(x, pw):
    flat = tuple(v for pair in reversed(pw) for v in pair)
    return torch.nn.functional.pad(x, flat)

kernel_name = 'gated_mix__mha_block__dense_activation_mish__prompt'

def setup_inputs():

    _w = (lambda a: (lambda t: t.to(torch.bfloat16) if t.is_floating_point() else t)(torch.as_tensor(a)))
    def _A_setup():
        B, S, D, H = 1, 2048, 640, 32
        return {
            "x": _w((lambda *s: torch.randn(*s, dtype=torch.bfloat16) * 0.05)(B, S, D)),
            "wqkv": _w((lambda *s: torch.randn(*s, dtype=torch.bfloat16) * 0.8)(D, 3 * D)),
            "wo": _w((lambda *s: torch.randn(*s, dtype=torch.bfloat16) * 0.05)(D, D)),
        }
    _A_in = _A_setup()

    def _B_setup():
        B, S, D, F = 1, 2048, 640, 1536
        return {
            "x": _w((lambda *s: torch.randn(*s, dtype=torch.bfloat16) * 0.05)(B, S, D)),
            "w1": _w((lambda *s: torch.randn(*s, dtype=torch.bfloat16) * 12.8)(D, F) * (D ** -0.5)),
            "b1": _w((lambda *s: torch.randn(*s, dtype=torch.bfloat16) * 0.2)(F)),
            "w2": _w((lambda *s: torch.randn(*s, dtype=torch.bfloat16) * 0.2)(F, D) * (F ** -0.5)),
        }
    _B_in = _B_setup()

    return {
        "A_x": _A_in["x"],
        "A_wqkv": _A_in["wqkv"],
        "A_wo": _A_in["wo"],
        "B_x": _B_in["x"],
        "B_w1": _B_in["w1"],
        "B_b1": _B_in["b1"],
        "B_w2": _B_in["w2"],
        "gate_w": _w((lambda *s: torch.randn(*s, dtype=torch.bfloat16) * 0.05)(640) * 16.0),
    }

def reference(A_x, A_wqkv, A_wo, B_x, B_w1, B_b1, B_w2, gate_w):
    def _A_ref(x, wqkv, wo):
        B, S, D = x.shape
        H = 32
        Dh = D // H
        qkv = (lambda x, *d: x.permute(*d))((x @ wqkv).reshape(B, S, 3, H, Dh), 2, 0, 3, 1, 4)
        q, k, v = qkv[0], qkv[1], qkv[2]
        scores = torch.einsum("bhqd,bhkd->bhqk", q, k) * (Dh ** -0.5)
        p = _softmax(scores, axis=-1)
        o = torch.einsum("bhqk,bhkd->bhqd", p, v)
        return (lambda x, *d: x.permute(*d))(o, 0, 2, 1, 3).reshape(B, S, D) @ wo

    def _B_ref(x, w1, b1, w2):
        h = torch.einsum("bsd,df->bsf", x, w1) + b1
        sp = torch.log1p(torch.exp(-torch.abs(h))) + torch.where(h > 0, h, torch.zeros_like(h))
        act = h * torch.tanh(sp)
        return torch.einsum("bsf,fd->bsd", act, w2)

    x = A_x
    g = _sigmoid((x * gate_w).sum(-1, keepdims=True))
    a = _A_ref(x, A_wqkv, A_wo)
    b = _B_ref(x, B_w1, B_b1, B_w2)
    return g * a + (1 - g) * b
```

```asm
; @launch grid=(256,1,1) block=(768,1,1) lds=163840
.amdgcn_target "amdgcn-amd-amdhsa--gfx950"
.text
.globl gated_mix__mha_block__dense_activation_mish__prompt_kernel
.p2align 8
.type gated_mix__mha_block__dense_activation_mish__prompt_kernel,@function
gated_mix__mha_block__dense_activation_mish__prompt_kernel:
    s_cmp_ge_u32 s2, 256
    s_cbranch_scc1 L_exit
    s_load_dwordx4 s[4:7], s[0:1], 0
    s_getpc_b64 s[38:39]
L_pc:
    s_lshr_b32 s3, s2, 3
    s_mul_i32 s3, s3, 1152
    v_lshrrev_b32 v1, 6, v0
    v_and_b32 v2, 63, v0
    v_lshlrev_b32 v3, 1, v2
    v_and_b32 v3, 64, v3
    v_mul_u32_u24 v4, 96, v1
    v_add3_u32 v3, v3, v4, s3
    v_lshlrev_b32 v4, 6, v2
    v_lshl_add_u32 v4, v1, 8, v4
    v_cmp_gt_u32 vcc, 4, v2
    s_and_b32 s12, s2, 1
    s_lshl_b32 s12, s12, 3
    v_cndmask_b32 v3, v3, v4, vcc
    v_min_u32 v3, L_exit-L_pc, v3
    global_load_dword v135, v3, s[38:39]
    s_bfe_u32 s13, s2, 0x30003
    v_readfirstlane_b32 s14, v1
    s_add_u32 s12, s12, s13
    s_bfe_u32 s13, s2, 0x20001
    s_lshl_b32 s13, s13, 2
    s_lshr_b32 s15, s2, 6
    s_add_u32 s13, s13, s15
    s_mov_b32 s101, s14
    s_cmp_lt_u32 s14, 8
    s_cbranch_scc1 L_awave
    s_load_dwordx2 s[24:25], s[0:1], 32
    s_load_dwordx4 s[52:55], s[0:1], 72
    s_load_dwordx4 s[36:39], s[0:1], 48
    s_load_dwordx2 s[48:49], s[0:1], 16
    s_load_dwordx2 s[32:33], s[0:1], 64
    s_setprio 3
    s_sub_u32 s61, s14, 8
    v_and_b32 v167, 63, v0
    v_lshrrev_b32 v2, 3, v167
    v_lshrrev_b32 v3, 4, v167
    v_and_b32 v4, 7, v167
    s_lshl_b32 s16, s61, 5
    v_add_u32 v2, s16, v2
    v_mul_u32_u24 v2, 1280, v2
    v_xor_b32 v5, v4, v3
    v_lshl_add_u32 v10, v5, 4, v2
    v_xor_b32 v5, 4, v5
    v_lshl_add_u32 v11, v5, 4, v2
    v_add_u32 v11, 9216, v11
    v_add_u32 v12, 18432, v10
    v_add_u32 v13, 18432, v11
    v_bfe_u32 v4, v167, 2, 2
    v_xor_b32 v4, v4, v3
    v_and_b32 v5, 3, v167
    v_cmp_eq_u32 vcc, 3, v4
    s_lshl_b32 s16, s61, 4
    v_add_u32 v8, s16, v3
    v_mul_u32_u24 v8, 3840, v8
    s_mul_i32 s17, s13, 240
    v_mul_u32_u24 v4, 80, v4
    v_xor_b32 v9, 0, v5
    v_and_b32 v6, 1, v9
    v_mul_u32_u24 v6, 48, v6
    v_lshrrev_b32 v7, 1, v9
    v_lshl_add_u32 v6, v7, 4, v6
    v_add_u32 v6, v6, v4
    v_min_u32 v7, 2, v9
    v_mul_u32_u24 v7, 80, v7
    v_add_u32 v7, 32, v7
    v_cndmask_b32 v6, v6, v7, vcc
    v_add3_u32 v14, v8, v6, s17
    v_add_u32 v15, 14336, v14
    v_xor_b32 v9, 2, v5
    v_and_b32 v6, 1, v9
    v_mul_u32_u24 v6, 48, v6
    v_lshrrev_b32 v7, 1, v9
    v_lshl_add_u32 v6, v7, 4, v6
    v_add_u32 v6, v6, v4
    v_min_u32 v7, 2, v9
    v_mul_u32_u24 v7, 80, v7
    v_add_u32 v7, 32, v7
    v_cndmask_b32 v6, v6, v7, vcc
    v_add3_u32 v16, v8, v6, s17
    v_add_u32 v16, 28672, v16
    v_add_u32 v17, 14336, v16
    s_lshl_b32 s18, s61, 12
    s_mul_i32 s19, s61, 3072
    s_mul_i32 s16, s12, 163840
    s_lshr_b32 s92, s2, 6
    s_mul_i32 s92, s92, 5
    s_add_u32 s92, s92, 1
    s_lshr_b32 s92, s92, 1
    s_mul_i32 s92, s92, 1
    s_bfe_u32 s3, s2, 0x30003
    s_and_b32 s3, s3, 7
    s_mul_i32 s3, s3, 1
    s_add_u32 s92, s92, s3
    s_and_b32 s3, s2, 1
    s_mul_i32 s3, s3, 5
    s_add_u32 s92, s92, s3
    s_bfe_u32 s3, s2, 0x20001
    s_mul_i32 s3, s3, 4
    s_lshr_b32 s3, s3, 1
    s_add_u32 s92, s92, s3
    s_mul_i32 s3, s92, 205
    s_lshr_b32 s3, s3, 11
    s_mul_i32 s3, s3, 10
    s_sub_u32 s92, s92, s3
    s_mul_i32 s92, s92, 128
    s_bfe_u32 s93, s2, 0x10003
    s_lshl_b32 s93, s93, 7
    s_waitcnt lgkmcnt(0)
    s_mov_b32 s8, s6
    s_mov_b32 s9, s7
    s_mov_b32 s40, s4
    s_mov_b32 s41, s5
    s_add_u32 s4, s4, s16
    s_addc_u32 s5, s5, 0
    s_mov_b32 s6, 163840
    s_mov_b32 s7, 0x20000
    s_mov_b32 s10, 2457600
    s_mov_b32 s11, 0x20000
    s_add_u32 s3, s2, s61
    s_cmp_lg_u32 s3, 0
    s_cbranch_scc1 L_notok0
    s_mov_b32 s3, 22829056
    s_load_dword s62, s[54:55], s3
L_notok0:
    s_add_u32 m0, s18, 0
    s_mul_i32 s20, s92, 1920
    buffer_load_dwordx4 v10, s[4:7], s92 offen offset:0 lds
    buffer_load_dwordx4 v11, s[4:7], s92 offen offset:1024 lds
    buffer_load_dwordx4 v12, s[4:7], s92 offen offset:2048 lds
    buffer_load_dwordx4 v13, s[4:7], s92 offen offset:3072 lds
    s_add_u32 m0, s18, 16384
    s_add_u32 s92, s92, 128
    buffer_load_dwordx4 v14, s[8:11], s20 offen offset:0 lds
    buffer_load_dwordx4 v15, s[8:11], s20 offen offset:1024 lds
    buffer_load_dwordx4 v16, s[8:11], s20 offen offset:2048 lds
    buffer_load_dwordx4 v17, s[8:11], s20 offen offset:3072 lds
    s_cmp_eq_u32 s92, 1280
    s_cselect_b32 s92, 0, s92
    s_add_u32 m0, s18, 32768
    s_mul_i32 s20, s92, 1920
    buffer_load_dwordx4 v10, s[4:7], s92 offen offset:0 lds
    buffer_load_dwordx4 v11, s[4:7], s92 offen offset:1024 lds
    buffer_load_dwordx4 v12, s[4:7], s92 offen offset:2048 lds
    buffer_load_dwordx4 v13, s[4:7], s92 offen offset:3072 lds
    s_add_u32 m0, s18, 49152
    s_add_u32 s92, s92, 128
    buffer_load_dwordx4 v14, s[8:11], s20 offen offset:0 lds
    buffer_load_dwordx4 v15, s[8:11], s20 offen offset:1024 lds
    buffer_load_dwordx4 v16, s[8:11], s20 offen offset:2048 lds
    buffer_load_dwordx4 v17, s[8:11], s20 offen offset:3072 lds
    s_cmp_eq_u32 s92, 1280
    s_cselect_b32 s92, 0, s92
    s_waitcnt vmcnt(8)
    s_barrier
    s_add_u32 m0, s18, 65536
    s_mul_i32 s20, s92, 1920
    buffer_load_dwordx4 v10, s[4:7], s92 offen offset:0 lds
    buffer_load_dwordx4 v11, s[4:7], s92 offen offset:1024 lds
    buffer_load_dwordx4 v12, s[4:7], s92 offen offset:2048 lds
    buffer_load_dwordx4 v13, s[4:7], s92 offen offset:3072 lds
    s_add_u32 m0, s18, 81920
    s_add_u32 s92, s92, 128
    buffer_load_dwordx4 v14, s[8:11], s20 offen offset:0 lds
    buffer_load_dwordx4 v15, s[8:11], s20 offen offset:1024 lds
    buffer_load_dwordx4 v16, s[8:11], s20 offen offset:2048 lds
    buffer_load_dwordx4 v17, s[8:11], s20 offen offset:3072 lds
    s_cmp_eq_u32 s92, 1280
    s_cselect_b32 s92, 0, s92
    s_mov_b32 s44, s38
    s_mov_b32 s45, s39
    s_mov_b32 s56, s54
    s_mov_b32 s57, s55
    s_mov_b32 s26, 1966080
    s_mov_b32 s27, 0x20000
    s_mov_b32 s38, 1966080
    s_mov_b32 s39, 0x20000
    s_mov_b32 s42, 2621440
    s_mov_b32 s43, 0x20000
    s_mov_b32 s46, 1280
    s_mov_b32 s47, 0x20000
    s_mov_b32 s50, 819200
    s_mov_b32 s51, 0x20000
    s_mov_b32 s54, 256
    s_mov_b32 s55, 0x20000
    s_mov_b32 s58, 22829312
    s_mov_b32 s59, 0x20000
    s_mov_b32 s34, 2621440
    s_mov_b32 s35, 0x20000
    s_add_u32 s3, s2, s61
    s_cmp_lg_u32 s3, 0
    s_cbranch_scc1 L_notok
    s_waitcnt lgkmcnt(0)
    s_mul_i32 s62, s62, 0x9e3779b1
    s_add_u32 s62, s62, 0x7f4a7c15
    s_cmp_eq_u32 s62, 0
    s_cselect_b32 s62, 1, s62
    v_mov_b32 v2, s62
    v_mov_b32 v3, 22829056
    v_mov_b32 v4, 0
    s_mov_b64 exec, 1
    buffer_store_dword v2, v4, s[52:55], 0 offen sc1
    buffer_store_dword v2, v3, s[56:59], 0 offen sc1
    s_mov_b64 exec, -1
L_notok:
    s_mul_i32 s17, s13, 192
    s_mul_i32 s16, s61, 49152
    s_add_u32 s17, s17, s16
    s_mov_b32 s16, 0x15555556
    v_add_u32 v22, 0, v167
    v_mul_hi_u32 v23, v22, s16
    v_mul_u32_u24 v24, 12, v23
    v_sub_u32 v22, v22, v24
    v_lshrrev_b32 v24, 2, v23
    v_and_b32 v24, 2, v24
    v_xor_b32 v22, v22, v24
    v_mul_u32_u24 v23, 3072, v23
    v_lshl_add_u32 v22, v22, 4, v23
    v_add_u32 v18, s17, v22
    v_add_u32 v22, 64, v167
    v_mul_hi_u32 v23, v22, s16
    v_mul_u32_u24 v24, 12, v23
    v_sub_u32 v22, v22, v24
    v_lshrrev_b32 v24, 2, v23
    v_and_b32 v24, 2, v24
    v_xor_b32 v22, v22, v24
    v_mul_u32_u24 v23, 3072, v23
    v_lshl_add_u32 v22, v22, 4, v23
    v_add_u32 v19, s17, v22
    v_subrev_u32 v19, 1024, v19
    v_add_u32 v22, 128, v167
    v_mul_hi_u32 v23, v22, s16
    v_mul_u32_u24 v24, 12, v23
    v_sub_u32 v22, v22, v24
    v_lshrrev_b32 v24, 2, v23
    v_and_b32 v24, 2, v24
    v_xor_b32 v22, v22, v24
    v_mul_u32_u24 v23, 3072, v23
    v_lshl_add_u32 v22, v22, 4, v23
    v_add_u32 v20, s17, v22
    v_subrev_u32 v20, 2048, v20
    s_waitcnt vmcnt(8)
    s_barrier
    s_add_u32 m0, s18, 98304
    s_mul_i32 s20, s92, 1920
    buffer_load_dwordx4 v10, s[4:7], s92 offen offset:0 lds
    buffer_load_dwordx4 v11, s[4:7], s92 offen offset:1024 lds
    buffer_load_dwordx4 v12, s[4:7], s92 offen offset:2048 lds
    buffer_load_dwordx4 v13, s[4:7], s92 offen offset:3072 lds
    s_add_u32 m0, s18, 114688
    s_add_u32 s92, s92, 128
    buffer_load_dwordx4 v14, s[8:11], s20 offen offset:0 lds
    buffer_load_dwordx4 v15, s[8:11], s20 offen offset:1024 lds
    buffer_load_dwordx4 v16, s[8:11], s20 offen offset:2048 lds
    buffer_load_dwordx4 v17, s[8:11], s20 offen offset:3072 lds
    s_cmp_eq_u32 s92, 1280
    s_cselect_b32 s92, 0, s92
    s_and_b32 s62, s2, 3
    s_lshl_b32 s62, s62, 3
    s_bfe_u32 s63, s2, 0x30003
    s_add_u32 s62, s62, s63
    s_bfe_u32 s63, s2, 0x10002
    s_lshl_b32 s63, s63, 2
    s_lshr_b32 s3, s2, 6
    s_add_u32 s63, s63, s3
    s_and_b32 s22, s2, 7
    s_lshl_b32 s22, s22, 2
    s_bfe_u32 s23, s2, 0x20003
    s_add_u32 s22, s22, s23
    s_lshr_b32 s23, s2, 5
    s_mul_i32 s3, s22, 180224
    s_add_u32 s3, s3, 2621440
    s_add_u32 s28, s56, s3
    s_addc_u32 s29, s57, 0
    s_lshl_b32 s17, s61, 11
    v_lshl_add_u32 v166, v167, 4, s17
    s_mov_b32 s94, 160
    s_mov_b32 s3, 0x55555556
    s_lshl_b32 s16, s61, 6
    s_lshl_b32 s90, s61, 9
    s_add_u32 s90, s90, 8192
    s_mul_i32 s91, s61, 3072
    s_add_u32 s91, s91, 10240
    v_add_u32 v22, 0, v167
    v_mul_hi_u32 v23, v22, s3
    v_mul_u32_u24 v24, 3, v23
    v_sub_u32 v22, v22, v24
    v_add_u32 v23, s16, v23
    v_lshlrev_b32 v24, 5, v23
    v_lshl_add_u32 v24, v22, 4, v24
    v_add_u32 v24, 10240, v24
    v_lshlrev_b32 v23, 4, v23
    v_cmp_eq_u32 vcc, 2, v22
    v_add_u32 v23, 18432, v23
    s_nop 0
    v_cndmask_b32 v150, v24, v23, vcc
    v_add_u32 v22, 64, v167
    v_mul_hi_u32 v23, v22, s3
    v_mul_u32_u24 v24, 3, v23
    v_sub_u32 v22, v22, v24
    v_add_u32 v23, s16, v23
    v_lshlrev_b32 v24, 5, v23
    v_lshl_add_u32 v24, v22, 4, v24
    v_add_u32 v24, 9216, v24
    v_lshlrev_b32 v23, 4, v23
    v_cmp_eq_u32 vcc, 2, v22
    v_add_u32 v23, 17408, v23
    s_nop 0
    v_cndmask_b32 v151, v24, v23, vcc
    v_add_u32 v22, 128, v167
    v_mul_hi_u32 v23, v22, s3
    v_mul_u32_u24 v24, 3, v23
    v_sub_u32 v22, v22, v24
    v_add_u32 v23, s16, v23
    v_lshlrev_b32 v24, 5, v23
    v_lshl_add_u32 v24, v22, 4, v24
    v_add_u32 v24, 8192, v24
    v_lshlrev_b32 v23, 4, v23
    v_cmp_eq_u32 vcc, 2, v22
    v_add_u32 v23, 16384, v23
    s_nop 0
    v_cndmask_b32 v152, v24, v23, vcc
    s_mov_b32 s30, 180224
    s_mov_b32 s31, 0x20000
    v_lshrrev_b32 v154, 4, v167
    v_bfe_u32 v155, v167, 2, 2
    v_and_b32 v156, 3, v167
    v_and_b32 v157, 1, v154
    v_lshl_add_u32 v155, v157, 2, v155
    v_lshl_add_u32 v155, v154, 3, v155
    v_mul_u32_u24 v156, 40, v156
    v_add_u32 v156, 77824, v156
    v_mad_u32_u24 v163, v155, s94, v156
    v_xor_b32 v155, 4, v155
    v_mad_u32_u24 v164, v155, s94, v156
    v_lshlrev_b32 v154, 9, v154
    v_and_b32 v155, 15, v167
    v_lshl_add_u32 v165, v155, 4, v154
    s_and_b32 s3, s61, 1
    s_lshl_b32 s3, s3, 8
    v_add_u32 v165, s3, v165
    s_mov_b32 s3, 0x1999999a
    s_mul_i32 s95, s63, 160
    v_add_u32 v154, 0, v167
    v_mul_hi_u32 v155, v154, s3
    v_mul_u32_u24 v156, 10, v155
    v_sub_u32 v154, v154, v156
    v_lshrrev_b32 v156, 1, v155
    v_and_b32 v156, 4, v156
    v_xor_b32 v155, v155, v156
    v_lshrrev_b32 v156, 3, v155
    v_lshlrev_b32 v156, 2, v156
    v_and_b32 v144, 3, v155
    v_add_u32 v156, v156, v144
    v_bfe_u32 v155, v155, 2, 1
    v_lshl_add_u32 v155, v155, 4, v156
    v_mul_u32_u24 v155, 1280, v155
    v_lshl_add_u32 v154, v154, 4, v155
    v_add_u32 v144, s95, v154
    v_add_u32 v154, 64, v167
    v_mul_hi_u32 v155, v154, s3
    v_mul_u32_u24 v156, 10, v155
    v_sub_u32 v154, v154, v156
    v_lshrrev_b32 v156, 1, v155
    v_and_b32 v156, 4, v156
    v_xor_b32 v155, v155, v156
    v_lshrrev_b32 v156, 3, v155
    v_lshlrev_b32 v156, 2, v156
    v_and_b32 v145, 3, v155
    v_add_u32 v156, v156, v145
    v_bfe_u32 v155, v155, 2, 1
    v_lshl_add_u32 v155, v155, 4, v156
    v_mul_u32_u24 v155, 1280, v155
    v_lshl_add_u32 v154, v154, 4, v155
    v_add_u32 v145, s95, v154
    v_add_u32 v154, 128, v167
    v_mul_hi_u32 v155, v154, s3
    v_mul_u32_u24 v156, 10, v155
    v_sub_u32 v154, v154, v156
    v_lshrrev_b32 v156, 1, v155
    v_and_b32 v156, 4, v156
    v_xor_b32 v155, v155, v156
    v_lshrrev_b32 v156, 3, v155
    v_lshlrev_b32 v156, 2, v156
    v_and_b32 v146, 3, v155
    v_add_u32 v156, v156, v146
    v_bfe_u32 v155, v155, 2, 1
    v_lshl_add_u32 v155, v155, 4, v156
    v_mul_u32_u24 v155, 1280, v155
    v_lshl_add_u32 v154, v154, 4, v155
    v_add_u32 v146, s95, v154
    v_add_u32 v154, 192, v167
    v_mul_hi_u32 v155, v154, s3
    v_mul_u32_u24 v156, 10, v155
    v_sub_u32 v154, v154, v156
    v_lshrrev_b32 v156, 1, v155
    v_and_b32 v156, 4, v156
    v_xor_b32 v155, v155, v156
    v_lshrrev_b32 v156, 3, v155
    v_lshlrev_b32 v156, 2, v156
    v_and_b32 v147, 3, v155
    v_add_u32 v156, v156, v147
    v_bfe_u32 v155, v155, 2, 1
    v_lshl_add_u32 v155, v155, 4, v156
    v_mul_u32_u24 v155, 1280, v155
    v_lshl_add_u32 v154, v154, 4, v155
    v_add_u32 v147, s95, v154
    v_add_u32 v154, 256, v167
    v_mul_hi_u32 v155, v154, s3
    v_mul_u32_u24 v156, 10, v155
    v_sub_u32 v154, v154, v156
    v_lshrrev_b32 v156, 1, v155
    v_and_b32 v156, 4, v156
    v_xor_b32 v155, v155, v156
    v_lshrrev_b32 v156, 3, v155
    v_lshlrev_b32 v156, 2, v156
    v_and_b32 v148, 3, v155
    v_add_u32 v156, v156, v148
    v_bfe_u32 v155, v155, 2, 1
    v_lshl_add_u32 v155, v155, 4, v156
    v_mul_u32_u24 v155, 1280, v155
    v_lshl_add_u32 v154, v154, 4, v155
    v_add_u32 v148, s95, v154
    s_waitcnt vmcnt(8)
    s_barrier
    s_add_u32 m0, s18, 131072
    s_mul_i32 s20, s92, 1920
    buffer_load_dwordx4 v10, s[4:7], s92 offen offset:0 lds
    buffer_load_dwordx4 v11, s[4:7], s92 offen offset:1024 lds
    buffer_load_dwordx4 v12, s[4:7], s92 offen offset:2048 lds
    buffer_load_dwordx4 v13, s[4:7], s92 offen offset:3072 lds
    s_add_u32 m0, s18, 147456
    s_add_u32 s92, s92, 128
    buffer_load_dwordx4 v14, s[8:11], s20 offen offset:0 lds
    buffer_load_dwordx4 v15, s[8:11], s20 offen offset:1024 lds
    buffer_load_dwordx4 v16, s[8:11], s20 offen offset:2048 lds
    buffer_load_dwordx4 v17, s[8:11], s20 offen offset:3072 lds
    s_cmp_eq_u32 s92, 1280
    s_cselect_b32 s92, 0, s92
    s_lshr_b32 s3, s22, 1
    s_add_u32 s16, s3, 16
    s_mul_hi_u32 s16, s16, 0x55555556
    s_add_u32 s21, s3, 32
    s_mul_hi_u32 s21, s21, 0x55555556
    s_mul_hi_u32 s3, s3, 0x55555556
    v_and_b32 v22, 15, v167
    v_lshlrev_b32 v22, 2, v22
    v_and_b32 v23, 1, v167
    v_lshlrev_b32 v23, 2, v23
    s_lshl_b32 s3, s3, 8
    s_lshl_b32 s95, s23, 3
    s_add_u32 s3, s3, s95
    v_add_u32 v23, s3, v23
    s_lshl_b32 s16, s16, 8
    s_lshl_b32 s21, s21, 8
    v_add_u32 v24, s16, v22
    v_add_u32 v25, s21, v22
    v_cmp_gt_u32 vcc, 16, v167
    s_lshr_b32 s3, s62, 1
    s_lshl_b32 s3, s3, 8
    v_cndmask_b32 v25, v25, v24, vcc
    v_cmp_gt_u32 vcc, 32, v167
    s_add_u32 s3, s3, 22818816
    v_add_u32 v26, s3, v22
    v_cndmask_b32 v25, v23, v25, vcc
    v_add_u32 v25, 22814720, v25
    v_and_b32 v22, 31, v167
    s_lshr_b32 s3, s62, 2
    s_lshl_b32 s3, s3, 8
    s_add_u32 s3, s3, 22822912
    v_lshl_add_u32 v27, v22, 2, s3
    s_nop 0
    v_cndmask_b32 v31, v27, v26, vcc
    s_lshl_b32 s3, s22, 6
    s_lshl_b32 s16, s23, 3
    s_add_u32 s3, s3, s16
    s_lshl_b32 s16, s61, 1
    s_add_u32 s3, s3, s16
    s_lshl_b32 s16, s3, 10
    s_add_u32 s16, s16, 0
    v_lshl_add_u32 v28, v167, 4, s16
    s_lshl_b32 s16, s3, 8
    s_add_u32 s16, s16, 2097152
    v_lshl_add_u32 v29, v167, 4, s16
    s_waitcnt vmcnt(8)
    s_barrier
    s_add_u32 m0, s18, 0
    s_mul_i32 s20, s92, 1920
    buffer_load_dwordx4 v10, s[4:7], s92 offen offset:0 lds
    buffer_load_dwordx4 v11, s[4:7], s92 offen offset:1024 lds
    buffer_load_dwordx4 v12, s[4:7], s92 offen offset:2048 lds
    buffer_load_dwordx4 v13, s[4:7], s92 offen offset:3072 lds
    s_add_u32 m0, s18, 16384
    s_add_u32 s92, s92, 128
    buffer_load_dwordx4 v14, s[8:11], s20 offen offset:0 lds
    buffer_load_dwordx4 v15, s[8:11], s20 offen offset:1024 lds
    buffer_load_dwordx4 v16, s[8:11], s20 offen offset:2048 lds
    buffer_load_dwordx4 v17, s[8:11], s20 offen offset:3072 lds
    s_cmp_eq_u32 s92, 1280
    s_cselect_b32 s92, 0, s92
    s_waitcnt vmcnt(8)
    s_barrier
    s_add_u32 m0, s18, 32768
    s_mul_i32 s20, s92, 1920
    buffer_load_dwordx4 v10, s[4:7], s92 offen offset:0 lds
    buffer_load_dwordx4 v11, s[4:7], s92 offen offset:1024 lds
    buffer_load_dwordx4 v12, s[4:7], s92 offen offset:2048 lds
    buffer_load_dwordx4 v13, s[4:7], s92 offen offset:3072 lds
    s_add_u32 m0, s18, 49152
    s_add_u32 s92, s92, 128
    buffer_load_dwordx4 v14, s[8:11], s20 offen offset:0 lds
    buffer_load_dwordx4 v15, s[8:11], s20 offen offset:1024 lds
    buffer_load_dwordx4 v16, s[8:11], s20 offen offset:2048 lds
    buffer_load_dwordx4 v17, s[8:11], s20 offen offset:3072 lds
    s_cmp_eq_u32 s92, 1280
    s_cselect_b32 s92, 0, s92
    s_add_u32 m0, s18, 65536
    s_mul_i32 s20, s92, 1920
    buffer_load_dwordx4 v10, s[4:7], s92 offen offset:0 lds
    buffer_load_dwordx4 v11, s[4:7], s92 offen offset:1024 lds
    buffer_load_dwordx4 v12, s[4:7], s92 offen offset:2048 lds
    buffer_load_dwordx4 v13, s[4:7], s92 offen offset:3072 lds
    s_add_u32 m0, s18, 81920
    s_add_u32 s92, s92, 128
    buffer_load_dwordx4 v14, s[8:11], s20 offen offset:0 lds
    buffer_load_dwordx4 v15, s[8:11], s20 offen offset:1024 lds
    buffer_load_dwordx4 v16, s[8:11], s20 offen offset:2048 lds
    buffer_load_dwordx4 v17, s[8:11], s20 offen offset:3072 lds
    s_cmp_eq_u32 s92, 1280
    s_cselect_b32 s92, 0, s92
    s_waitcnt vmcnt(16)
    s_barrier
    s_add_u32 m0, s18, 98304
    s_mul_i32 s20, s92, 1920
    buffer_load_dwordx4 v10, s[4:7], s92 offen offset:0 lds
    buffer_load_dwordx4 v11, s[4:7], s92 offen offset:1024 lds
    buffer_load_dwordx4 v12, s[4:7], s92 offen offset:2048 lds
    buffer_load_dwordx4 v13, s[4:7], s92 offen offset:3072 lds
    s_add_u32 m0, s18, 114688
    s_add_u32 s92, s92, 128
    buffer_load_dwordx4 v14, s[8:11], s20 offen offset:0 lds
    buffer_load_dwordx4 v15, s[8:11], s20 offen offset:1024 lds
    buffer_load_dwordx4 v16, s[8:11], s20 offen offset:2048 lds
    buffer_load_dwordx4 v17, s[8:11], s20 offen offset:3072 lds
    s_cmp_eq_u32 s92, 1280
    s_cselect_b32 s92, 0, s92
    buffer_load_dword v30, off, s[52:55], 0 sc1
    s_waitcnt vmcnt(17)
    s_barrier
    s_add_u32 m0, s18, 131072
    s_mul_i32 s20, s92, 1920
    buffer_load_dwordx4 v10, s[4:7], s92 offen offset:0 lds
    buffer_load_dwordx4 v11, s[4:7], s92 offen offset:1024 lds
    buffer_load_dwordx4 v12, s[4:7], s92 offen offset:2048 lds
    buffer_load_dwordx4 v13, s[4:7], s92 offen offset:3072 lds
    s_add_u32 m0, s18, 147456
    s_add_u32 s92, s92, 128
    buffer_load_dwordx4 v14, s[8:11], s20 offen offset:0 lds
    buffer_load_dwordx4 v15, s[8:11], s20 offen offset:1024 lds
    buffer_load_dwordx4 v16, s[8:11], s20 offen offset:2048 lds
    buffer_load_dwordx4 v17, s[8:11], s20 offen offset:3072 lds
    s_cmp_eq_u32 s92, 1280
    s_cselect_b32 s92, 0, s92
    s_waitcnt vmcnt(17)
    s_barrier
    s_add_u32 s92, s92, 640
    s_sub_u32 s20, s92, 1280
    s_cmp_ge_u32 s92, 1280
    s_cselect_b32 s92, s20, s92
    s_add_u32 m0, s18, 0
    s_mul_i32 s20, s92, 1536
    s_add_u32 m0, s19, 16384
    s_add_u32 s92, s92, 128
    buffer_load_dwordx4 v18, s[24:27], s20 offen offset:0 lds
    buffer_load_dwordx4 v19, s[24:27], s20 offen offset:1024 lds
    buffer_load_dwordx4 v20, s[24:27], s20 offen offset:2048 lds
    s_cmp_eq_u32 s92, 1280
    s_cselect_b32 s92, 0, s92
    s_add_u32 m0, s18, 32768
    s_mul_i32 s20, s92, 1536
    s_add_u32 m0, s19, 49152
    s_add_u32 s92, s92, 128
    buffer_load_dwordx4 v18, s[24:27], s20 offen offset:0 lds
    buffer_load_dwordx4 v19, s[24:27], s20 offen offset:1024 lds
    buffer_load_dwordx4 v20, s[24:27], s20 offen offset:2048 lds
    s_cmp_eq_u32 s92, 1280
    s_cselect_b32 s92, 0, s92
    s_waitcnt vmcnt(15)
    s_barrier
    s_add_u32 m0, s18, 65536
    s_mul_i32 s20, s92, 1536
    s_add_u32 m0, s19, 81920
    s_add_u32 s92, s92, 128
    buffer_load_dwordx4 v18, s[24:27], s20 offen offset:0 lds
    buffer_load_dwordx4 v19, s[24:27], s20 offen offset:1024 lds
    buffer_load_dwordx4 v20, s[24:27], s20 offen offset:2048 lds
    s_cmp_eq_u32 s92, 1280
    s_cselect_b32 s92, 0, s92
    s_waitcnt vmcnt(9)
    s_barrier
    s_add_u32 m0, s18, 98304
    s_mul_i32 s20, s92, 1536
    s_add_u32 m0, s19, 114688
    s_add_u32 s92, s92, 128
    buffer_load_dwordx4 v18, s[24:27], s20 offen offset:0 lds
    buffer_load_dwordx4 v19, s[24:27], s20 offen offset:1024 lds
    buffer_load_dwordx4 v20, s[24:27], s20 offen offset:2048 lds
    s_cmp_eq_u32 s92, 1280
    s_cselect_b32 s92, 0, s92
    s_waitcnt vmcnt(9)
    s_barrier
    s_add_u32 m0, s18, 131072
    s_mul_i32 s20, s92, 1536
    s_add_u32 m0, s19, 147456
    s_add_u32 s92, s92, 128
    buffer_load_dwordx4 v18, s[24:27], s20 offen offset:0 lds
    buffer_load_dwordx4 v19, s[24:27], s20 offen offset:1024 lds
    buffer_load_dwordx4 v20, s[24:27], s20 offen offset:2048 lds
    s_cmp_eq_u32 s92, 1280
    s_cselect_b32 s92, 0, s92
    s_waitcnt vmcnt(9)
    s_barrier
    v_readfirstlane_b32 s60, v30
    s_mov_b32 s3, 524288
    s_nop 1
    s_cmp_lg_u32 s60, 0
    s_cbranch_scc1 L_tok_ok
L_tok:
    buffer_load_dword v30, off, s[52:55], 0 sc1
    s_sub_u32 s3, s3, 1
    s_cmp_eq_u32 s3, 0
    s_cbranch_scc1 L_tok_ok
    s_waitcnt vmcnt(0)
    v_readfirstlane_b32 s60, v30
    s_nop 1
    s_cmp_eq_u32 s60, 0
    s_cbranch_scc1 L_tok
L_tok_ok:
    v_mov_b32 v22, 159744
    v_mov_b32 v23, 0
    ds_write_b32 v22, v23
    v_and_b32 v22, 3, v167
    v_lshlrev_b32 v22, 8, v22
    v_add_u32 v22, 159808, v22
    v_mov_b32 v24, 0x3f803f80
    v_mov_b32 v23, 0x3f80
    ds_write_b32 v22, v24
    ds_write_b32 v22, v23 offset:4
    s_waitcnt lgkmcnt(0)
    s_waitcnt vmcnt(6)
    s_barrier
    s_add_u32 m0, s18, 0
    s_mul_i32 s20, s92, 1536
    buffer_load_dwordx4 v10, s[4:7], s92 offen offset:0 lds
    buffer_load_dwordx4 v11, s[4:7], s92 offen offset:1024 lds
    buffer_load_dwordx4 v12, s[4:7], s92 offen offset:2048 lds
    buffer_load_dwordx4 v13, s[4:7], s92 offen offset:3072 lds
    s_add_u32 m0, s19, 16384
    s_add_u32 s92, s92, 128
    buffer_load_dwordx4 v18, s[24:27], s20 offen offset:0 lds
    buffer_load_dwordx4 v19, s[24:27], s20 offen offset:1024 lds
    buffer_load_dwordx4 v20, s[24:27], s20 offen offset:2048 lds
    s_cmp_eq_u32 s92, 1280
    s_cselect_b32 s92, 0, s92
    s_waitcnt vmcnt(10)
    s_barrier
    s_add_u32 m0, s18, 32768
    s_mul_i32 s20, s92, 1536
    buffer_load_dwordx4 v10, s[4:7], s92 offen offset:0 lds
    buffer_load_dwordx4 v11, s[4:7], s92 offen offset:1024 lds
    buffer_load_dwordx4 v12, s[4:7], s92 offen offset:2048 lds
    buffer_load_dwordx4 v13, s[4:7], s92 offen offset:3072 lds
    s_add_u32 m0, s19, 49152
    s_add_u32 s92, s92, 128
    buffer_load_dwordx4 v18, s[24:27], s20 offen offset:0 lds
    buffer_load_dwordx4 v19, s[24:27], s20 offen offset:1024 lds
    buffer_load_dwordx4 v20, s[24:27], s20 offen offset:2048 lds
    s_cmp_eq_u32 s92, 1280
    s_cselect_b32 s92, 0, s92
    s_lshl_b32 s16, s13, 8
    s_lshl_b32 s3, s12, 2
    s_add_u32 s16, s16, s3
    s_add_u32 s16, s16, 22814720
    s_cmp_lg_u32 s61, 0
    s_cbranch_scc1 L_pub1
    v_mov_b32 v158, s16
    v_mov_b32 v157, s60
    s_mov_b64 exec, 1
    buffer_store_dword v157, v158, s[56:59], 0 offen sc1
    s_mov_b64 exec, -1
L_pub1:
    s_waitcnt vmcnt(14)
    s_barrier
    s_add_u32 m0, s18, 65536
    s_mul_i32 s20, s92, 1536
    buffer_load_dwordx4 v10, s[4:7], s92 offen offset:0 lds
    buffer_load_dwordx4 v11, s[4:7], s92 offen offset:1024 lds
    buffer_load_dwordx4 v12, s[4:7], s92 offen offset:2048 lds
    buffer_load_dwordx4 v13, s[4:7], s92 offen offset:3072 lds
    s_add_u32 m0, s19, 81920
    s_add_u32 s92, s92, 128
    buffer_load_dwordx4 v18, s[24:27], s20 offen offset:0 lds
    buffer_load_dwordx4 v19, s[24:27], s20 offen offset:1024 lds
    buffer_load_dwordx4 v20, s[24:27], s20 offen offset:2048 lds
    s_cmp_eq_u32 s92, 1280
    s_cselect_b32 s92, 0, s92
    s_waitcnt vmcnt(14)
    s_barrier
    s_add_u32 m0, s18, 98304
    s_mul_i32 s20, s92, 1536
    buffer_load_dwordx4 v10, s[4:7], s92 offen offset:0 lds
    buffer_load_dwordx4 v11, s[4:7], s92 offen offset:1024 lds
    buffer_load_dwordx4 v12, s[4:7], s92 offen offset:2048 lds
    buffer_load_dwordx4 v13, s[4:7], s92 offen offset:3072 lds
    s_add_u32 m0, s19, 114688
    s_add_u32 s92, s92, 128
    buffer_load_dwordx4 v18, s[24:27], s20 offen offset:0 lds
    buffer_load_dwordx4 v19, s[24:27], s20 offen offset:1024 lds
    buffer_load_dwordx4 v20, s[24:27], s20 offen offset:2048 lds
    s_cmp_eq_u32 s92, 1280
    s_cselect_b32 s92, 0, s92
    s_waitcnt vmcnt(14)
    s_barrier
    s_add_u32 m0, s18, 131072
    s_mul_i32 s20, s92, 1536
    buffer_load_dwordx4 v10, s[4:7], s92 offen offset:0 lds
    buffer_load_dwordx4 v11, s[4:7], s92 offen offset:1024 lds
    buffer_load_dwordx4 v12, s[4:7], s92 offen offset:2048 lds
    buffer_load_dwordx4 v13, s[4:7], s92 offen offset:3072 lds
    s_add_u32 m0, s19, 147456
    s_add_u32 s92, s92, 128
    buffer_load_dwordx4 v18, s[24:27], s20 offen offset:0 lds
    buffer_load_dwordx4 v19, s[24:27], s20 offen offset:1024 lds
    buffer_load_dwordx4 v20, s[24:27], s20 offen offset:2048 lds
    s_cmp_eq_u32 s92, 1280
    s_cselect_b32 s92, 0, s92
    s_cmp_lg_u32 s61, 3
    s_cbranch_scc1 L_nog0
    v_lshrrev_b32 v36, 3, v167
    v_and_b32 v37, 7, v167
    v_lshlrev_b32 v37, 4, v37
    v_mul_u32_u24 v38, 1280, v36
    v_add_u32 v38, v38, v37
    s_lshl_b32 s3, s12, 4
    s_add_u32 s3, s3, s13
    s_mul_i32 s10, s3, 10240
    s_lshl_b32 s11, s3, 5
    s_add_u32 s11, s11, 17301504
    buffer_load_dwordx4 v[40:43], v37, s[44:47], 0 offen offset:0
    buffer_load_dwordx4 v[80:83], v38, s[40:43], s10 offen offset:0
    buffer_load_dwordx4 v[44:47], v37, s[44:47], 0 offen offset:128
    buffer_load_dwordx4 v[84:87], v38, s[40:43], s10 offen offset:128
    buffer_load_dwordx4 v[48:51], v37, s[44:47], 0 offen offset:256
    buffer_load_dwordx4 v[88:91], v38, s[40:43], s10 offen offset:256
    buffer_load_dwordx4 v[52:55], v37, s[44:47], 0 offen offset:384
    buffer_load_dwordx4 v[92:95], v38, s[40:43], s10 offen offset:384
    buffer_load_dwordx4 v[56:59], v37, s[44:47], 0 offen offset:512
    buffer_load_dwordx4 v[96:99], v38, s[40:43], s10 offen offset:512
    buffer_load_dwordx4 v[60:63], v37, s[44:47], 0 offen offset:640
    buffer_load_dwordx4 v[100:103], v38, s[40:43], s10 offen offset:640
    buffer_load_dwordx4 v[64:67], v37, s[44:47], 0 offen offset:768
    buffer_load_dwordx4 v[104:107], v38, s[40:43], s10 offen offset:768
    buffer_load_dwordx4 v[68:71], v37, s[44:47], 0 offen offset:896
    buffer_load_dwordx4 v[108:111], v38, s[40:43], s10 offen offset:896
    buffer_load_dwordx4 v[72:75], v37, s[44:47], 0 offen offset:1024
    buffer_load_dwordx4 v[112:115], v38, s[40:43], s10 offen offset:1024
    buffer_load_dwordx4 v[76:79], v37, s[44:47], 0 offen offset:1152
    buffer_load_dwordx4 v[116:119], v38, s[40:43], s10 offen offset:1152
L_nog0:
    s_waitcnt vmcnt(14)
    s_barrier
    buffer_load_dword v24, v25, s[56:59], 0 offen sc1
    s_waitcnt vmcnt(8)
    s_barrier
    s_waitcnt vmcnt(0)
    v_cmp_ne_u32 vcc, s60, v24
    s_mov_b32 s89, 0
    s_nop 2
    s_and_b32 s3, vcc_lo, 0x30003
    s_or_b32 s3, s3, vcc_hi
    s_cbranch_scc1 L_notyet
    s_mov_b32 s89, 1
    s_mov_b32 s15, 0
    s_add_u32 m0, s17, 0
    s_sub_u32 s21, s90, s17
    buffer_load_dwordx4 v166, s[28:31], s15 offen offset:0 sc1 lds
    buffer_load_dwordx4 v166, s[28:31], s15 offen offset:1024 sc1 lds
    s_add_u32 m0, s91, 0
    s_add_u32 s21, s21, s15
    buffer_load_dwordx4 v150, s[28:31], s15 offen offset:0 sc1 lds
    buffer_load_dwordx4 v151, s[28:31], s15 offen offset:1024 sc1 lds
    buffer_load_dwordx4 v152, s[28:31], s15 offen offset:2048 sc1 lds
    s_add_u32 m0, s90, 0
    s_mov_b32 exec_hi, 0
    buffer_load_dwordx4 v166, s[28:31], s21 offen sc1 lds
    s_mov_b64 exec, -1
    s_lshl_b32 s3, s61, 11
    s_add_u32 m0, s3, 22528
    s_nop 0
    buffer_load_dwordx4 v28, s[56:59], 0 offen sc1 lds
    buffer_load_dwordx4 v28, s[56:59], 0 offen offset:1024 sc1 lds
    s_lshl_b32 s3, s61, 9
    s_add_u32 m0, s3, 30720
    s_mov_b32 exec_hi, 0
    buffer_load_dwordx4 v29, s[56:59], 0 offen sc1 lds
    s_mov_b64 exec, -1
L_notyet:
    s_cmp_lg_u32 s61, 3
    s_cbranch_scc1 L_nog1
    v_mov_b32 v38, 0
    v_mov_b32 v39, 0
    v_dot2_f32_bf16 v38, v80, v40, v38
    v_dot2_f32_bf16 v39, v81, v41, v39
    v_dot2_f32_bf16 v38, v82, v42, v38
    v_dot2_f32_bf16 v39, v83, v43, v39
    v_dot2_f32_bf16 v38, v84, v44, v38
    v_dot2_f32_bf16 v39, v85, v45, v39
    v_dot2_f32_bf16 v38, v86, v46, v38
    v_dot2_f32_bf16 v39, v87, v47, v39
    v_dot2_f32_bf16 v38, v88, v48, v38
    v_dot2_f32_bf16 v39, v89, v49, v39
    v_dot2_f32_bf16 v38, v90, v50, v38
    v_dot2_f32_bf16 v39, v91, v51, v39
    v_dot2_f32_bf16 v38, v92, v52, v38
    v_dot2_f32_bf16 v39, v93, v53, v39
    v_dot2_f32_bf16 v38, v94, v54, v38
    v_dot2_f32_bf16 v39, v95, v55, v39
    v_dot2_f32_bf16 v38, v96, v56, v38
    v_dot2_f32_bf16 v39, v97, v57, v39
    v_dot2_f32_bf16 v38, v98, v58, v38
    v_dot2_f32_bf16 v39, v99, v59, v39
    v_dot2_f32_bf16 v38, v100, v60, v38
    v_dot2_f32_bf16 v39, v101, v61, v39
    v_dot2_f32_bf16 v38, v102, v62, v38
    v_dot2_f32_bf16 v39, v103, v63, v39
    v_dot2_f32_bf16 v38, v104, v64, v38
    v_dot2_f32_bf16 v39, v105, v65, v39
    v_dot2_f32_bf16 v38, v106, v66, v38
    v_dot2_f32_bf16 v39, v107, v67, v39
    v_dot2_f32_bf16 v38, v108, v68, v38
    v_dot2_f32_bf16 v39, v109, v69, v39
    v_dot2_f32_bf16 v38, v110, v70, v38
    v_dot2_f32_bf16 v39, v111, v71, v39
    v_dot2_f32_bf16 v38, v112, v72, v38
    v_dot2_f32_bf16 v39, v113, v73, v39
    v_dot2_f32_bf16 v38, v114, v74, v38
    v_dot2_f32_bf16 v39, v115, v75, v39
    v_dot2_f32_bf16 v38, v116, v76, v38
    v_dot2_f32_bf16 v39, v117, v77, v39
    v_dot2_f32_bf16 v38, v118, v78, v38
    v_dot2_f32_bf16 v39, v119, v79, v39
    v_lshlrev_b32 v36, 2, v36
    s_nop 1
    v_add_f32 v38, v38, v39
    s_nop 1
    v_add_f32_dpp v38, v38, v38 quad_perm:[1,0,3,2] row_mask:0xf bank_mask:0xf
    s_nop 1
    v_add_f32_dpp v38, v38, v38 quad_perm:[2,3,0,1] row_mask:0xf bank_mask:0xf
    s_nop 1
    v_add_f32_dpp v38, v38, v38 row_half_mirror row_mask:0xf bank_mask:0xf
    v_mul_f32 v38, 0xbfb8aa3b, v38
    v_exp_f32 v38, v38
    s_mov_b32 exec_lo, 0x01010101
    v_add_f32 v38, 1.0, v38
    v_rcp_f32 v38, v38
    s_mov_b32 exec_hi, 0x01010101
    s_nop 0
    buffer_store_dword v38, v36, s[56:59], s11 offen sc1
    s_mov_b64 exec, -1
L_nog1:
    s_barrier
    s_mov_b32 s3, 524288
L_poll1:
    buffer_load_dword v159, v25, s[56:59], 0 offen sc1
    s_sub_u32 s3, s3, 1
    s_cmp_eq_u32 s3, 0
    s_cbranch_scc1 L_poll1_ok
    s_waitcnt vmcnt(0)
    v_cmp_ne_u32 vcc, s60, v159
    s_nop 4
    s_cbranch_vccz L_poll1_ok
    s_sleep 8
    s_branch L_poll1
L_poll1_ok:
    s_cmp_eq_u32 s89, 1
    s_cbranch_scc1 L_havekv0
    s_mov_b32 s15, 0
    s_add_u32 m0, s17, 0
    s_sub_u32 s21, s90, s17
    buffer_load_dwordx4 v166, s[28:31], s15 offen offset:0 sc1 lds
    buffer_load_dwordx4 v166, s[28:31], s15 offen offset:1024 sc1 lds
    s_add_u32 m0, s91, 0
    s_add_u32 s21, s21, s15
    buffer_load_dwordx4 v150, s[28:31], s15 offen offset:0 sc1 lds
    buffer_load_dwordx4 v151, s[28:31], s15 offen offset:1024 sc1 lds
    buffer_load_dwordx4 v152, s[28:31], s15 offen offset:2048 sc1 lds
    s_add_u32 m0, s90, 0
    s_mov_b32 exec_hi, 0
    buffer_load_dwordx4 v166, s[28:31], s21 offen sc1 lds
    s_mov_b64 exec, -1
    s_lshl_b32 s3, s61, 11
    s_add_u32 m0, s3, 22528
    s_nop 0
    buffer_load_dwordx4 v28, s[56:59], 0 offen sc1 lds
    buffer_load_dwordx4 v28, s[56:59], 0 offen offset:1024 sc1 lds
    s_lshl_b32 s3, s61, 9
    s_add_u32 m0, s3, 30720
    s_mov_b32 exec_hi, 0
    buffer_load_dwordx4 v29, s[56:59], 0 offen sc1 lds
    s_mov_b64 exec, -1
L_havekv0:
    s_mov_b32 s15, 22528
    s_add_u32 m0, s17, 32768
    s_sub_u32 s21, s90, s17
    buffer_load_dwordx4 v166, s[28:31], s15 offen offset:0 sc1 lds
    buffer_load_dwordx4 v166, s[28:31], s15 offen offset:1024 sc1 lds
    s_add_u32 m0, s91, 32768
    s_add_u32 s21, s21, s15
    buffer_load_dwordx4 v150, s[28:31], s15 offen offset:0 sc1 lds
    buffer_load_dwordx4 v151, s[28:31], s15 offen offset:1024 sc1 lds
    buffer_load_dwordx4 v152, s[28:31], s15 offen offset:2048 sc1 lds
    s_add_u32 m0, s90, 32768
    s_mov_b32 exec_hi, 0
    buffer_load_dwordx4 v166, s[28:31], s21 offen sc1 lds
    s_mov_b64 exec, -1
    s_mov_b32 s15, 45056
    s_add_u32 m0, s17, 55296
    s_sub_u32 s21, s90, s17
    buffer_load_dwordx4 v166, s[28:31], s15 offen offset:0 sc1 lds
    buffer_load_dwordx4 v166, s[28:31], s15 offen offset:1024 sc1 lds
    s_add_u32 m0, s91, 55296
    s_add_u32 s21, s21, s15
    buffer_load_dwordx4 v150, s[28:31], s15 offen offset:0 sc1 lds
    buffer_load_dwordx4 v151, s[28:31], s15 offen offset:1024 sc1 lds
    buffer_load_dwordx4 v152, s[28:31], s15 offen offset:2048 sc1 lds
    s_add_u32 m0, s90, 55296
    s_mov_b32 exec_hi, 0
    buffer_load_dwordx4 v166, s[28:31], s21 offen sc1 lds
    s_mov_b64 exec, -1
    v_mov_b32 v156, v26
    v_mov_b32 v149, v27
    s_lshl_b32 s18, s62, 6
    s_lshl_b32 s19, s61, 4
    s_add_u32 s18, s18, s19
    s_lshr_b32 s13, s18, 5
    s_mul_i32 s4, s13, 98304
    s_add_u32 s4, s4, 11010048
    s_and_b32 s14, s61, 1
    s_lshl_b32 s3, s14, 13
    s_add_u32 s4, s4, s3
    v_xor_b32 v153, 0x100, v165
    s_mul_i32 s5, s13, 40960
    s_add_u32 s5, s5, 8388608
    s_mul_i32 s6, s61, 10240
    s_mul_i32 s7, s61, 81920
    s_lshl_b32 s8, s12, 8
    s_add_u32 s8, s8, 22818816
    s_lshr_b32 s3, s2, 6
    s_bfe_u32 s9, s2, 0x20001
    s_lshl_b32 s9, s9, 2
    s_add_u32 s9, s9, s3
    s_lshl_b32 s9, s9, 2
    s_add_u32 s8, s8, s9
    s_lshl_b32 s9, s23, 8
    s_lshl_b32 s3, s22, 2
    s_add_u32 s9, s9, s3
    s_add_u32 s9, s9, 22822912
    v_mov_b32 v0, 0
    v_mov_b32 v1, 0
    v_mov_b32 v2, 0
    v_mov_b32 v3, 0
    v_mov_b32 v4, 0
    v_mov_b32 v5, 0
    v_mov_b32 v6, 0
    v_mov_b32 v7, 0
    v_mov_b32 v8, 0
    v_mov_b32 v9, 0
    v_mov_b32 v10, 0
    v_mov_b32 v11, 0
    v_mov_b32 v12, 0
    v_mov_b32 v13, 0
    v_mov_b32 v14, 0
    v_mov_b32 v15, 0
    v_mov_b32 v16, 0
    v_mov_b32 v17, 0
    v_mov_b32 v18, 0
    v_mov_b32 v19, 0
    v_mov_b32 v20, 0
    v_mov_b32 v21, 0
    v_mov_b32 v22, 0
    v_mov_b32 v23, 0
    v_mov_b32 v24, 0
    v_mov_b32 v25, 0
    v_mov_b32 v26, 0
    v_mov_b32 v27, 0
    v_mov_b32 v28, 0
    v_mov_b32 v29, 0
    v_mov_b32 v30, 0
    v_mov_b32 v31, 0
    v_mov_b32 v32, 0
    v_mov_b32 v33, 0
    v_mov_b32 v34, 0
    v_mov_b32 v35, 0
    v_mov_b32 v36, 0
    v_mov_b32 v37, 0
    v_mov_b32 v38, 0
    v_mov_b32 v39, 0
    s_waitcnt vmcnt(12)
    s_setprio 1
    s_barrier
    s_waitcnt vmcnt(6)
    s_barrier
    s_cmp_lg_u32 s61, 0
    s_cbranch_scc1 L_pub2
    v_mov_b32 v158, s8
    v_mov_b32 v157, s60
    s_mov_b64 exec, 1
    buffer_store_dword v157, v158, s[56:59], 0 offen sc1
    s_mov_b64 exec, -1
L_pub2:
    s_add_u32 m0, s6, 77824
    s_nop 0
    buffer_load_dwordx4 v144, s[36:39], s7 offen lds
    s_add_u32 m0, s6, 78848
    s_nop 0
    buffer_load_dwordx4 v145, s[36:39], s7 offen lds
    s_add_u32 m0, s6, 79872
    s_nop 0
    buffer_load_dwordx4 v146, s[36:39], s7 offen lds
    s_add_u32 m0, s6, 80896
    s_nop 0
    buffer_load_dwordx4 v147, s[36:39], s7 offen lds
    s_add_u32 m0, s6, 81920
    s_nop 0
    buffer_load_dwordx4 v148, s[36:39], s7 offen lds
    s_add_u32 s7, s7, 40960
    s_add_u32 m0, s6, 82944
    s_nop 0
    buffer_load_dwordx4 v144, s[36:39], s7 offen lds
    s_add_u32 m0, s6, 83968
    s_nop 0
    buffer_load_dwordx4 v145, s[36:39], s7 offen lds
    s_add_u32 m0, s6, 84992
    s_nop 0
    buffer_load_dwordx4 v146, s[36:39], s7 offen lds
    s_add_u32 m0, s6, 86016
    s_nop 0
    buffer_load_dwordx4 v147, s[36:39], s7 offen lds
    s_add_u32 m0, s6, 87040
    s_nop 0
    buffer_load_dwordx4 v148, s[36:39], s7 offen lds
    s_add_u32 s7, s7, 286720
    s_mov_b32 s3, 524288
L_poll2:
    buffer_load_dword v159, v156, s[56:59], 0 offen sc1
    s_sub_u32 s3, s3, 1
    s_cmp_eq_u32 s3, 0
    s_cbranch_scc1 L_poll2_ok
    s_waitcnt vmcnt(0)
    v_cmp_ne_u32 vcc, s60, v159
    s_nop 4
    s_cbranch_vccz L_poll2_ok
    s_sleep 8
    s_branch L_poll2
L_poll2_ok:
    v_and_b32 v154, 15, v167
    v_lshlrev_b32 v154, 2, v154
    s_lshl_b32 s3, s18, 2
    s_add_u32 s3, s3, 17301504
    buffer_load_dword v160, v154, s[56:59], s3 offen sc1
    buffer_load_dwordx4 v[80:83], v165, s[56:59], s4 offen offset:0 sc1
    buffer_load_dwordx4 v[84:87], v153, s[56:59], s4 offen offset:0 sc1
    buffer_load_dwordx4 v[88:91], v165, s[56:59], s4 offen offset:2048 sc1
    buffer_load_dwordx4 v[92:95], v153, s[56:59], s4 offen offset:2048 sc1
    s_add_u32 s4, s4, 4096
    buffer_load_dwordx4 v[96:99], v165, s[56:59], s4 offen offset:0 sc1
    buffer_load_dwordx4 v[100:103], v153, s[56:59], s4 offen offset:0 sc1
    buffer_load_dwordx4 v[104:107], v165, s[56:59], s4 offen offset:2048 sc1
    buffer_load_dwordx4 v[108:111], v153, s[56:59], s4 offen offset:2048 sc1
    s_add_u32 s4, s4, 12288
    s_barrier
    s_mul_i32 s3, s14, 20480
    s_add_u32 s3, s3, 0
    v_add_u32 v161, s3, v163
    v_add_u32 v162, s3, v164
    s_waitcnt vmcnt(0)
    ds_read_b64_tr_b16 v[40:41], v161 offset:0
    ds_read_b64_tr_b16 v[42:43], v162 offset:0
    ds_read_b64_tr_b16 v[44:45], v161 offset:8
    ds_read_b64_tr_b16 v[46:47], v162 offset:8
    ds_read_b64_tr_b16 v[48:49], v161 offset:16
    ds_read_b64_tr_b16 v[50:51], v162 offset:16
    ds_read_b64_tr_b16 v[52:53], v161 offset:24
    ds_read_b64_tr_b16 v[54:55], v162 offset:24
    ds_read_b64_tr_b16 v[56:57], v161 offset:32
    ds_read_b64_tr_b16 v[58:59], v162 offset:32
    s_waitcnt lgkmcnt(6)
    v_mfma_f32_16x16x32_bf16 v[0:3], v[40:43], v[80:83], v[0:3]
    ds_read_b64_tr_b16 v[60:61], v161 offset:5120
    v_mfma_f32_16x16x32_bf16 v[20:23], v[40:43], v[84:87], v[20:23]
    ds_read_b64_tr_b16 v[62:63], v162 offset:5120
    v_mfma_f32_16x16x32_bf16 v[4:7], v[44:47], v[80:83], v[4:7]
    ds_read_b64_tr_b16 v[64:65], v161 offset:5128
    v_mfma_f32_16x16x32_bf16 v[24:27], v[44:47], v[84:87], v[24:27]
    ds_read_b64_tr_b16 v[66:67], v162 offset:5128
    s_waitcnt lgkmcnt(6)
    v_mfma_f32_16x16x32_bf16 v[8:11], v[48:51], v[80:83], v[8:11]
    ds_read_b64_tr_b16 v[68:69], v161 offset:5136
    v_mfma_f32_16x16x32_bf16 v[28:31], v[48:51], v[84:87], v[28:31]
    ds_read_b64_tr_b16 v[70:71], v162 offset:5136
    v_mfma_f32_16x16x32_bf16 v[12:15], v[52:55], v[80:83], v[12:15]
    ds_read_b64_tr_b16 v[72:73], v161 offset:5144
    v_mfma_f32_16x16x32_bf16 v[32:35], v[52:55], v[84:87], v[32:35]
    ds_read_b64_tr_b16 v[74:75], v162 offset:5144
    s_waitcnt lgkmcnt(8)
    v_mfma_f32_16x16x32_bf16 v[16:19], v[56:59], v[80:83], v[16:19]
    ds_read_b64_tr_b16 v[76:77], v161 offset:5152
    v_mfma_f32_16x16x32_bf16 v[36:39], v[56:59], v[84:87], v[36:39]
    ds_read_b64_tr_b16 v[78:79], v162 offset:5152
    s_mov_b32 s15, 67584
    s_add_u32 m0, s17, 0
    s_sub_u32 s21, s90, s17
    buffer_load_dwordx4 v166, s[28:31], s15 offen offset:0 sc1 lds
    buffer_load_dwordx4 v166, s[28:31], s15 offen offset:1024 sc1 lds
    s_add_u32 m0, s91, 0
    s_add_u32 s21, s21, s15
    buffer_load_dwordx4 v150, s[28:31], s15 offen offset:0 sc1 lds
    buffer_load_dwordx4 v151, s[28:31], s15 offen offset:1024 sc1 lds
    buffer_load_dwordx4 v152, s[28:31], s15 offen offset:2048 sc1 lds
    s_add_u32 m0, s90, 0
    s_mov_b32 exec_hi, 0
    buffer_load_dwordx4 v166, s[28:31], s21 offen sc1 lds
    s_mov_b64 exec, -1
    s_add_u32 m0, s6, 118784
    s_nop 0
    buffer_load_dwordx4 v144, s[36:39], s7 offen lds
    s_add_u32 m0, s6, 119808
    s_nop 0
    buffer_load_dwordx4 v145, s[36:39], s7 offen lds
    s_add_u32 m0, s6, 120832
    s_nop 0
    buffer_load_dwordx4 v146, s[36:39], s7 offen lds
    s_add_u32 m0, s6, 121856
    s_nop 0
    buffer_load_dwordx4 v147, s[36:39], s7 offen lds
    s_waitcnt lgkmcnt(6)
    v_mfma_f32_16x16x32_bf16 v[0:3], v[60:63], v[88:91], v[0:3]
    ds_read_b64_tr_b16 v[40:41], v161 offset:10240
    v_mfma_f32_16x16x32_bf16 v[20:23], v[60:63], v[92:95], v[20:23]
    ds_read_b64_tr_b16 v[42:43], v162 offset:10240
    v_mfma_f32_16x16x32_bf16 v[4:7], v[64:67], v[88:91], v[4:7]
    ds_read_b64_tr_b16 v[44:45], v161 offset:10248
    v_mfma_f32_16x16x32_bf16 v[24:27], v[64:67], v[92:95], v[24:27]
    ds_read_b64_tr_b16 v[46:47], v162 offset:10248
    s_waitcnt lgkmcnt(6)
    v_mfma_f32_16x16x32_bf16 v[8:11], v[68:71], v[88:91], v[8:11]
    ds_read_b64_tr_b16 v[48:49], v161 offset:10256
    v_mfma_f32_16x16x32_bf16 v[28:31], v[68:71], v[92:95], v[28:31]
    ds_read_b64_tr_b16 v[50:51], v162 offset:10256
    v_mfma_f32_16x16x32_bf16 v[12:15], v[72:75], v[88:91], v[12:15]
    ds_read_b64_tr_b16 v[52:53], v161 offset:10264
    v_mfma_f32_16x16x32_bf16 v[32:35], v[72:75], v[92:95], v[32:35]
    ds_read_b64_tr_b16 v[54:55], v162 offset:10264
    s_waitcnt lgkmcnt(8)
    v_mfma_f32_16x16x32_bf16 v[16:19], v[76:79], v[88:91], v[16:19]
    ds_read_b64_tr_b16 v[56:57], v161 offset:10272
    v_mfma_f32_16x16x32_bf16 v[36:39], v[76:79], v[92:95], v[36:39]
    ds_read_b64_tr_b16 v[58:59], v162 offset:10272
    s_add_u32 m0, s6, 122880
    s_nop 0
    buffer_load_dwordx4 v148, s[36:39], s7 offen lds
    s_add_u32 s7, s7, 40960
    s_add_u32 m0, s6, 123904
    s_nop 0
    buffer_load_dwordx4 v144, s[36:39], s7 offen lds
    s_add_u32 m0, s6, 124928
    s_nop 0
    buffer_load_dwordx4 v145, s[36:39], s7 offen lds
    s_add_u32 m0, s6, 125952
    s_nop 0
    buffer_load_dwordx4 v146, s[36:39], s7 offen lds
    s_add_u32 m0, s6, 126976
    s_nop 0
    buffer_load_dwordx4 v147, s[36:39], s7 offen lds
    s_waitcnt lgkmcnt(6)
    v_mfma_f32_16x16x32_bf16 v[0:3], v[40:43], v[96:99], v[0:3]
    ds_read_b64_tr_b16 v[60:61], v161 offset:15360
    v_mfma_f32_16x16x32_bf16 v[20:23], v[40:43], v[100:103], v[20:23]
    ds_read_b64_tr_b16 v[62:63], v162 offset:15360
    v_mfma_f32_16x16x32_bf16 v[4:7], v[44:47], v[96:99], v[4:7]
    ds_read_b64_tr_b16 v[64:65], v161 offset:15368
    v_mfma_f32_16x16x32_bf16 v[24:27], v[44:47], v[100:103], v[24:27]
    ds_read_b64_tr_b16 v[66:67], v162 offset:15368
    s_waitcnt lgkmcnt(6)
    v_mfma_f32_16x16x32_bf16 v[8:11], v[48:51], v[96:99], v[8:11]
    ds_read_b64_tr_b16 v[68:69], v161 offset:15376
    v_mfma_f32_16x16x32_bf16 v[28:31], v[48:51], v[100:103], v[28:31]
    ds_read_b64_tr_b16 v[70:71], v162 offset:15376
    v_mfma_f32_16x16x32_bf16 v[12:15], v[52:55], v[96:99], v[12:15]
    ds_read_b64_tr_b16 v[72:73], v161 offset:15384
    v_mfma_f32_16x16x32_bf16 v[32:35], v[52:55], v[100:103], v[32:35]
    ds_read_b64_tr_b16 v[74:75], v162 offset:15384
    s_waitcnt lgkmcnt(8)
    v_mfma_f32_16x16x32_bf16 v[16:19], v[56:59], v[96:99], v[16:19]
    ds_read_b64_tr_b16 v[76:77], v161 offset:15392
    v_mfma_f32_16x16x32_bf16 v[36:39], v[56:59], v[100:103], v[36:39]
    ds_read_b64_tr_b16 v[78:79], v162 offset:15392
    s_add_u32 m0, s6, 128000
    s_nop 0
    buffer_load_dwordx4 v148, s[36:39], s7 offen lds
    s_add_u32 s7, s7, 286720
    buffer_load_dwordx4 v[112:115], v165, s[56:59], s4 offen offset:0 sc1
    buffer_load_dwordx4 v[116:119], v153, s[56:59], s4 offen offset:0 sc1
    buffer_load_dwordx4 v[120:123], v165, s[56:59], s4 offen offset:2048 sc1
    buffer_load_dwordx4 v[124:127], v153, s[56:59], s4 offen offset:2048 sc1
    s_add_u32 s4, s4, 4096
    s_waitcnt lgkmcnt(6)
    v_mfma_f32_16x16x32_bf16 v[0:3], v[60:63], v[104:107], v[0:3]
    v_mfma_f32_16x16x32_bf16 v[20:23], v[60:63], v[108:111], v[20:23]
    v_mfma_f32_16x16x32_bf16 v[4:7], v[64:67], v[104:107], v[4:7]
    v_mfma_f32_16x16x32_bf16 v[24:27], v[64:67], v[108:111], v[24:27]
    s_waitcnt lgkmcnt(2)
    v_mfma_f32_16x16x32_bf16 v[8:11], v[68:71], v[104:107], v[8:11]
    v_mfma_f32_16x16x32_bf16 v[28:31], v[68:71], v[108:111], v[28:31]
    v_mfma_f32_16x16x32_bf16 v[12:15], v[72:75], v[104:107], v[12:15]
    v_mfma_f32_16x16x32_bf16 v[32:35], v[72:75], v[108:111], v[32:35]
    s_waitcnt lgkmcnt(0)
    v_mfma_f32_16x16x32_bf16 v[16:19], v[76:79], v[104:107], v[16:19]
    v_mfma_f32_16x16x32_bf16 v[36:39], v[76:79], v[108:111], v[36:39]
    buffer_load_dwordx4 v[128:131], v165, s[56:59], s4 offen offset:0 sc1
    buffer_load_dwordx4 v[132:135], v153, s[56:59], s4 offen offset:0 sc1
    buffer_load_dwordx4 v[136:139], v165, s[56:59], s4 offen offset:2048 sc1
    buffer_load_dwordx4 v[140:143], v153, s[56:59], s4 offen offset:2048 sc1
    s_add_u32 s4, s4, 12288
    s_lshl_b32 s3, s23, 3
    s_lshl_b32 s10, s61, 1
    s_add_u32 s3, s3, s10
    s_mul_i32 s3, s3, 40960
    s_add_u32 s3, s3, 8388608
    s_lshl_b32 s10, s22, 10
    s_add_u32 s10, s10, s3
    s_add_u32 s11, s10, 40960
    v_lshlrev_b32 v154, 4, v167
    v_mov_b32 v156, -1
    v_mov_b32 v157, -1
    v_mov_b32 v158, -1
    v_mov_b32 v159, -1
    buffer_store_dwordx4 v[156:159], v154, s[56:59], s10 offen sc1
    buffer_store_dwordx4 v[156:159], v154, s[56:59], s11 offen sc1
    s_mov_b32 s11, 40960
    v_bfe_u32 v155, v167, 4, 1
    v_and_b32 v154, 0xff, v154
    v_mad_u32_u24 v155, v155, s11, v154
    s_lshl_b32 s10, s22, 8
    s_add_u32 s10, s10, s3
    s_add_u32 s10, s10, 32768
    s_mov_b32 exec_hi, 0
    buffer_store_dwordx4 v[156:159], v155, s[56:59], s10 offen sc1
    s_mov_b64 exec, -1
    s_waitcnt vmcnt(11)
    s_barrier
    s_mul_i32 s3, s14, 20480
    s_add_u32 s3, s3, 40960
    v_add_u32 v161, s3, v163
    v_add_u32 v162, s3, v164
    s_waitcnt vmcnt(3)
    ds_read_b64_tr_b16 v[40:41], v161 offset:0
    ds_read_b64_tr_b16 v[42:43], v162 offset:0
    ds_read_b64_tr_b16 v[44:45], v161 offset:8
    ds_read_b64_tr_b16 v[46:47], v162 offset:8
    ds_read_b64_tr_b16 v[48:49], v161 offset:16
    ds_read_b64_tr_b16 v[50:51], v162 offset:16
    ds_read_b64_tr_b16 v[52:53], v161 offset:24
    ds_read_b64_tr_b16 v[54:55], v162 offset:24
    ds_read_b64_tr_b16 v[56:57], v161 offset:32
    ds_read_b64_tr_b16 v[58:59], v162 offset:32
    s_waitcnt lgkmcnt(6)
    v_mfma_f32_16x16x32_bf16 v[0:3], v[40:43], v[112:115], v[0:3]
    ds_read_b64_tr_b16 v[60:61], v161 offset:5120
    v_mfma_f32_16x16x32_bf16 v[20:23], v[40:43], v[116:119], v[20:23]
    ds_read_b64_tr_b16 v[62:63], v162 offset:5120
    v_mfma_f32_16x16x32_bf16 v[4:7], v[44:47], v[112:115], v[4:7]
    ds_read_b64_tr_b16 v[64:65], v161 offset:5128
    v_mfma_f32_16x16x32_bf16 v[24:27], v[44:47], v[116:119], v[24:27]
    ds_read_b64_tr_b16 v[66:67], v162 offset:5128
    s_waitcnt lgkmcnt(6)
    v_mfma_f32_16x16x32_bf16 v[8:11], v[48:51], v[112:115], v[8:11]
    ds_read_b64_tr_b16 v[68:69], v161 offset:5136
    v_mfma_f32_16x16x32_bf16 v[28:31], v[48:51], v[116:119], v[28:31]
    ds_read_b64_tr_b16 v[70:71], v162 offset:5136
    v_mfma_f32_16x16x32_bf16 v[12:15], v[52:55], v[112:115], v[12:15]
    ds_read_b64_tr_b16 v[72:73], v161 offset:5144
    v_mfma_f32_16x16x32_bf16 v[32:35], v[52:55], v[116:119], v[32:35]
    ds_read_b64_tr_b16 v[74:75], v162 offset:5144
    s_waitcnt lgkmcnt(8)
    v_mfma_f32_16x16x32_bf16 v[16:19], v[56:59], v[112:115], v[16:19]
    ds_read_b64_tr_b16 v[76:77], v161 offset:5152
    v_mfma_f32_16x16x32_bf16 v[36:39], v[56:59], v[116:119], v[36:39]
    ds_read_b64_tr_b16 v[78:79], v162 offset:5152
    s_mov_b32 s15, 90112
    s_add_u32 m0, s17, 32768
    s_sub_u32 s21, s90, s17
    buffer_load_dwordx4 v166, s[28:31], s15 offen offset:0 sc1 lds
    buffer_load_dwordx4 v166, s[28:31], s15 offen offset:1024 sc1 lds
    s_add_u32 m0, s91, 32768
    s_add_u32 s21, s21, s15
    buffer_load_dwordx4 v150, s[28:31], s15 offen offset:0 sc1 lds
    buffer_load_dwordx4 v151, s[28:31], s15 offen offset:1024 sc1 lds
    buffer_load_dwordx4 v152, s[28:31], s15 offen offset:2048 sc1 lds
    s_add_u32 m0, s90, 32768
    s_mov_b32 exec_hi, 0
    buffer_load_dwordx4 v166, s[28:31], s21 offen sc1 lds
    s_mov_b64 exec, -1
    s_add_u32 m0, s6, 77824
    s_nop 0
    buffer_load_dwordx4 v144, s[36:39], s7 offen lds
    s_add_u32 m0, s6, 78848
    s_nop 0
    buffer_load_dwordx4 v145, s[36:39], s7 offen lds
    s_add_u32 m0, s6, 79872
    s_nop 0
    buffer_load_dwordx4 v146, s[36:39], s7 offen lds
    s_add_u32 m0, s6, 80896
    s_nop 0
    buffer_load_dwordx4 v147, s[36:39], s7 offen lds
    s_waitcnt lgkmcnt(6)
    v_mfma_f32_16x16x32_bf16 v[0:3], v[60:63], v[120:123], v[0:3]
    ds_read_b64_tr_b16 v[40:41], v161 offset:10240
    v_mfma_f32_16x16x32_bf16 v[20:23], v[60:63], v[124:127], v[20:23]
    ds_read_b64_tr_b16 v[42:43], v162 offset:10240
    v_mfma_f32_16x16x32_bf16 v[4:7], v[64:67], v[120:123], v[4:7]
    ds_read_b64_tr_b16 v[44:45], v161 offset:10248
    v_mfma_f32_16x16x32_bf16 v[24:27], v[64:67], v[124:127], v[24:27]
    ds_read_b64_tr_b16 v[46:47], v162 offset:10248
    s_waitcnt lgkmcnt(6)
    v_mfma_f32_16x16x32_bf16 v[8:11], v[68:71], v[120:123], v[8:11]
    ds_read_b64_tr_b16 v[48:49], v161 offset:10256
    v_mfma_f32_16x16x32_bf16 v[28:31], v[68:71], v[124:127], v[28:31]
    ds_read_b64_tr_b16 v[50:51], v162 offset:10256
    v_mfma_f32_16x16x32_bf16 v[12:15], v[72:75], v[120:123], v[12:15]
    ds_read_b64_tr_b16 v[52:53], v161 offset:10264
    v_mfma_f32_16x16x32_bf16 v[32:35], v[72:75], v[124:127], v[32:35]
    ds_read_b64_tr_b16 v[54:55], v162 offset:10264
    s_waitcnt lgkmcnt(8)
    v_mfma_f32_16x16x32_bf16 v[16:19], v[76:79], v[120:123], v[16:19]
    ds_read_b64_tr_b16 v[56:57], v161 offset:10272
    v_mfma_f32_16x16x32_bf16 v[36:39], v[76:79], v[124:127], v[36:39]
    ds_read_b64_tr_b16 v[58:59], v162 offset:10272
    s_add_u32 m0, s6, 81920
    s_nop 0
    buffer_load_dwordx4 v148, s[36:39], s7 offen lds
    s_add_u32 s7, s7, 40960
    s_add_u32 m0, s6, 82944
    s_nop 0
    buffer_load_dwordx4 v144, s[36:39], s7 offen lds
    s_add_u32 m0, s6, 83968
    s_nop 0
    buffer_load_dwordx4 v145, s[36:39], s7 offen lds
    s_add_u32 m0, s6, 84992
    s_nop 0
    buffer_load_dwordx4 v146, s[36:39], s7 offen lds
    s_add_u32 m0, s6, 86016
    s_nop 0
    buffer_load_dwordx4 v147, s[36:39], s7 offen lds
    s_waitcnt lgkmcnt(6)
    v_mfma_f32_16x16x32_bf16 v[0:3], v[40:43], v[128:131], v[0:3]
    ds_read_b64_tr_b16 v[60:61], v161 offset:15360
    v_mfma_f32_16x16x32_bf16 v[20:23], v[40:43], v[132:135], v[20:23]
    ds_read_b64_tr_b16 v[62:63], v162 offset:15360
    v_mfma_f32_16x16x32_bf16 v[4:7], v[44:47], v[128:131], v[4:7]
    ds_read_b64_tr_b16 v[64:65], v161 offset:15368
    v_mfma_f32_16x16x32_bf16 v[24:27], v[44:47], v[132:135], v[24:27]
    ds_read_b64_tr_b16 v[66:67], v162 offset:15368
    s_waitcnt lgkmcnt(6)
    v_mfma_f32_16x16x32_bf16 v[8:11], v[48:51], v[128:131], v[8:11]
    ds_read_b64_tr_b16 v[68:69], v161 offset:15376
    v_mfma_f32_16x16x32_bf16 v[28:31], v[48:51], v[132:135], v[28:31]
    ds_read_b64_tr_b16 v[70:71], v162 offset:15376
    v_mfma_f32_16x16x32_bf16 v[12:15], v[52:55], v[128:131], v[12:15]
    ds_read_b64_tr_b16 v[72:73], v161 offset:15384
    v_mfma_f32_16x16x32_bf16 v[32:35], v[52:55], v[132:135], v[32:35]
    ds_read_b64_tr_b16 v[74:75], v162 offset:15384
    s_waitcnt lgkmcnt(8)
    v_mfma_f32_16x16x32_bf16 v[16:19], v[56:59], v[128:131], v[16:19]
    ds_read_b64_tr_b16 v[76:77], v161 offset:15392
    v_mfma_f32_16x16x32_bf16 v[36:39], v[56:59], v[132:135], v[36:39]
    ds_read_b64_tr_b16 v[78:79], v162 offset:15392
    s_add_u32 m0, s6, 87040
    s_nop 0
    buffer_load_dwordx4 v148, s[36:39], s7 offen lds
    s_add_u32 s7, s7, 286720
    buffer_load_dwordx4 v[80:83], v165, s[56:59], s4 offen offset:0 sc1
    buffer_load_dwordx4 v[84:87], v153, s[56:59], s4 offen offset:0 sc1
    buffer_load_dwordx4 v[88:91], v165, s[56:59], s4 offen offset:2048 sc1
    buffer_load_dwordx4 v[92:95], v153, s[56:59], s4 offen offset:2048 sc1
    s_add_u32 s4, s4, 4096
    s_waitcnt lgkmcnt(6)
    v_mfma_f32_16x16x32_bf16 v[0:3], v[60:63], v[136:139], v[0:3]
    v_mfma_f32_16x16x32_bf16 v[20:23], v[60:63], v[140:143], v[20:23]
    v_mfma_f32_16x16x32_bf16 v[4:7], v[64:67], v[136:139], v[4:7]
    v_mfma_f32_16x16x32_bf16 v[24:27], v[64:67], v[140:143], v[24:27]
    s_waitcnt lgkmcnt(2)
    v_mfma_f32_16x16x32_bf16 v[8:11], v[68:71], v[136:139], v[8:11]
    v_mfma_f32_16x16x32_bf16 v[28:31], v[68:71], v[140:143], v[28:31]
    v_mfma_f32_16x16x32_bf16 v[12:15], v[72:75], v[136:139], v[12:15]
    v_mfma_f32_16x16x32_bf16 v[32:35], v[72:75], v[140:143], v[32:35]
    s_waitcnt lgkmcnt(0)
    v_mfma_f32_16x16x32_bf16 v[16:19], v[76:79], v[136:139], v[16:19]
    v_mfma_f32_16x16x32_bf16 v[36:39], v[76:79], v[140:143], v[36:39]
    buffer_load_dwordx4 v[96:99], v165, s[56:59], s4 offen offset:0 sc1
    buffer_load_dwordx4 v[100:103], v153, s[56:59], s4 offen offset:0 sc1
    buffer_load_dwordx4 v[104:107], v165, s[56:59], s4 offen offset:2048 sc1
    buffer_load_dwordx4 v[108:111], v153, s[56:59], s4 offen offset:2048 sc1
    s_add_u32 s4, s4, 12288
    s_waitcnt vmcnt(8)
    s_barrier
    s_cmp_lg_u32 s61, 0
    s_cbranch_scc1 L_pub2b
    v_mov_b32 v158, s9
    v_mov_b32 v157, s60
    s_mov_b64 exec, 1
    buffer_store_dword v157, v158, s[56:59], 0 offen sc1
    s_mov_b64 exec, -1
L_pub2b:
    s_mul_i32 s3, s14, 20480
    s_add_u32 s3, s3, 0
    v_add_u32 v161, s3, v163
    v_add_u32 v162, s3, v164
    s_waitcnt vmcnt(0)
    ds_read_b64_tr_b16 v[40:41], v161 offset:0
    ds_read_b64_tr_b16 v[42:43], v162 offset:0
    ds_read_b64_tr_b16 v[44:45], v161 offset:8
    ds_read_b64_tr_b16 v[46:47], v162 offset:8
    ds_read_b64_tr_b16 v[48:49], v161 offset:16
    ds_read_b64_tr_b16 v[50:51], v162 offset:16
    ds_read_b64_tr_b16 v[52:53], v161 offset:24
    ds_read_b64_tr_b16 v[54:55], v162 offset:24
    ds_read_b64_tr_b16 v[56:57], v161 offset:32
    ds_read_b64_tr_b16 v[58:59], v162 offset:32
    s_waitcnt lgkmcnt(6)
    v_mfma_f32_16x16x32_bf16 v[0:3], v[40:43], v[80:83], v[0:3]
    ds_read_b64_tr_b16 v[60:61], v161 offset:5120
    v_mfma_f32_16x16x32_bf16 v[20:23], v[40:43], v[84:87], v[20:23]
    ds_read_b64_tr_b16 v[62:63], v162 offset:5120
    v_mfma_f32_16x16x32_bf16 v[4:7], v[44:47], v[80:83], v[4:7]
    ds_read_b64_tr_b16 v[64:65], v161 offset:5128
    v_mfma_f32_16x16x32_bf16 v[24:27], v[44:47], v[84:87], v[24:27]
    ds_read_b64_tr_b16 v[66:67], v162 offset:5128
    s_waitcnt lgkmcnt(6)
    v_mfma_f32_16x16x32_bf16 v[8:11], v[48:51], v[80:83], v[8:11]
    ds_read_b64_tr_b16 v[68:69], v161 offset:5136
    v_mfma_f32_16x16x32_bf16 v[28:31], v[48:51], v[84:87], v[28:31]
    ds_read_b64_tr_b16 v[70:71], v162 offset:5136
    v_mfma_f32_16x16x32_bf16 v[12:15], v[52:55], v[80:83], v[12:15]
    ds_read_b64_tr_b16 v[72:73], v161 offset:5144
    v_mfma_f32_16x16x32_bf16 v[32:35], v[52:55], v[84:87], v[32:35]
    ds_read_b64_tr_b16 v[74:75], v162 offset:5144
    s_waitcnt lgkmcnt(8)
    v_mfma_f32_16x16x32_bf16 v[16:19], v[56:59], v[80:83], v[16:19]
    ds_read_b64_tr_b16 v[76:77], v161 offset:5152
    v_mfma_f32_16x16x32_bf16 v[36:39], v[56:59], v[84:87], v[36:39]
    ds_read_b64_tr_b16 v[78:79], v162 offset:5152
    s_mov_b32 s15, 112640
    s_add_u32 m0, s17, 55296
    s_sub_u32 s21, s90, s17
    buffer_load_dwordx4 v166, s[28:31], s15 offen offset:0 sc1 lds
    buffer_load_dwordx4 v166, s[28:31], s15 offen offset:1024 sc1 lds
    s_add_u32 m0, s91, 55296
    s_add_u32 s21, s21, s15
    buffer_load_dwordx4 v150, s[28:31], s15 offen offset:0 sc1 lds
    buffer_load_dwordx4 v151, s[28:31], s15 offen offset:1024 sc1 lds
    buffer_load_dwordx4 v152, s[28:31], s15 offen offset:2048 sc1 lds
    s_add_u32 m0, s90, 55296
    s_mov_b32 exec_hi, 0
    buffer_load_dwordx4 v166, s[28:31], s21 offen sc1 lds
    s_mov_b64 exec, -1
    s_add_u32 m0, s6, 118784
    s_nop 0
    buffer_load_dwordx4 v144, s[36:39], s7 offen lds
    s_add_u32 m0, s6, 119808
    s_nop 0
    buffer_load_dwordx4 v145, s[36:39], s7 offen lds
    s_add_u32 m0, s6, 120832
    s_nop 0
    buffer_load_dwordx4 v146, s[36:39], s7 offen lds
    s_add_u32 m0, s6, 121856
    s_nop 0
    buffer_load_dwordx4 v147, s[36:39], s7 offen lds
    s_waitcnt lgkmcnt(6)
    v_mfma_f32_16x16x32_bf16 v[0:3], v[60:63], v[88:91], v[0:3]
    ds_read_b64_tr_b16 v[40:41], v161 offset:10240
    v_mfma_f32_16x16x32_bf16 v[20:23], v[60:63], v[92:95], v[20:23]
    ds_read_b64_tr_b16 v[42:43], v162 offset:10240
    v_mfma_f32_16x16x32_bf16 v[4:7], v[64:67], v[88:91], v[4:7]
    ds_read_b64_tr_b16 v[44:45], v161 offset:10248
    v_mfma_f32_16x16x32_bf16 v[24:27], v[64:67], v[92:95], v[24:27]
    ds_read_b64_tr_b16 v[46:47], v162 offset:10248
    s_waitcnt lgkmcnt(6)
    v_mfma_f32_16x16x32_bf16 v[8:11], v[68:71], v[88:91], v[8:11]
    ds_read_b64_tr_b16 v[48:49], v161 offset:10256
    v_mfma_f32_16x16x32_bf16 v[28:31], v[68:71], v[92:95], v[28:31]
    ds_read_b64_tr_b16 v[50:51], v162 offset:10256
    v_mfma_f32_16x16x32_bf16 v[12:15], v[72:75], v[88:91], v[12:15]
    ds_read_b64_tr_b16 v[52:53], v161 offset:10264
    v_mfma_f32_16x16x32_bf16 v[32:35], v[72:75], v[92:95], v[32:35]
    ds_read_b64_tr_b16 v[54:55], v162 offset:10264
    s_waitcnt lgkmcnt(8)
    v_mfma_f32_16x16x32_bf16 v[16:19], v[76:79], v[88:91], v[16:19]
    ds_read_b64_tr_b16 v[56:57], v161 offset:10272
    v_mfma_f32_16x16x32_bf16 v[36:39], v[76:79], v[92:95], v[36:39]
    ds_read_b64_tr_b16 v[58:59], v162 offset:10272
    s_add_u32 m0, s6, 122880
    s_nop 0
    buffer_load_dwordx4 v148, s[36:39], s7 offen lds
    s_add_u32 s7, s7, 40960
    s_add_u32 m0, s6, 123904
    s_nop 0
    buffer_load_dwordx4 v144, s[36:39], s7 offen lds
    s_add_u32 m0, s6, 124928
    s_nop 0
    buffer_load_dwordx4 v145, s[36:39], s7 offen lds
    s_add_u32 m0, s6, 125952
    s_nop 0
    buffer_load_dwordx4 v146, s[36:39], s7 offen lds
    s_add_u32 m0, s6, 126976
    s_nop 0
    buffer_load_dwordx4 v147, s[36:39], s7 offen lds
    s_waitcnt lgkmcnt(6)
    v_mfma_f32_16x16x32_bf16 v[0:3], v[40:43], v[96:99], v[0:3]
    ds_read_b64_tr_b16 v[60:61], v161 offset:15360
    v_mfma_f32_16x16x32_bf16 v[20:23], v[40:43], v[100:103], v[20:23]
    ds_read_b64_tr_b16 v[62:63], v162 offset:15360
    v_mfma_f32_16x16x32_bf16 v[4:7], v[44:47], v[96:99], v[4:7]
    ds_read_b64_tr_b16 v[64:65], v161 offset:15368
    v_mfma_f32_16x16x32_bf16 v[24:27], v[44:47], v[100:103], v[24:27]
    ds_read_b64_tr_b16 v[66:67], v162 offset:15368
    s_waitcnt lgkmcnt(6)
    v_mfma_f32_16x16x32_bf16 v[8:11], v[48:51], v[96:99], v[8:11]
    ds_read_b64_tr_b16 v[68:69], v161 offset:15376
    v_mfma_f32_16x16x32_bf16 v[28:31], v[48:51], v[100:103], v[28:31]
    ds_read_b64_tr_b16 v[70:71], v162 offset:15376
    v_mfma_f32_16x16x32_bf16 v[12:15], v[52:55], v[96:99], v[12:15]
    ds_read_b64_tr_b16 v[72:73], v161 offset:15384
    v_mfma_f32_16x16x32_bf16 v[32:35], v[52:55], v[100:103], v[32:35]
    ds_read_b64_tr_b16 v[74:75], v162 offset:15384
    s_waitcnt lgkmcnt(8)
    v_mfma_f32_16x16x32_bf16 v[16:19], v[56:59], v[96:99], v[16:19]
    ds_read_b64_tr_b16 v[76:77], v161 offset:15392
    v_mfma_f32_16x16x32_bf16 v[36:39], v[56:59], v[100:103], v[36:39]
    ds_read_b64_tr_b16 v[78:79], v162 offset:15392
    s_add_u32 m0, s6, 128000
    s_nop 0
    buffer_load_dwordx4 v148, s[36:39], s7 offen lds
    s_add_u32 s7, s7, 286720
    buffer_load_dwordx4 v[112:115], v165, s[56:59], s4 offen offset:0 sc1
    buffer_load_dwordx4 v[116:119], v153, s[56:59], s4 offen offset:0 sc1
    buffer_load_dwordx4 v[120:123], v165, s[56:59], s4 offen offset:2048 sc1
    buffer_load_dwordx4 v[124:127], v153, s[56:59], s4 offen offset:2048 sc1
    s_add_u32 s4, s4, 4096
    s_waitcnt lgkmcnt(6)
    v_mfma_f32_16x16x32_bf16 v[0:3], v[60:63], v[104:107], v[0:3]
    v_mfma_f32_16x16x32_bf16 v[20:23], v[60:63], v[108:111], v[20:23]
    v_mfma_f32_16x16x32_bf16 v[4:7], v[64:67], v[104:107], v[4:7]
    v_mfma_f32_16x16x32_bf16 v[24:27], v[64:67], v[108:111], v[24:27]
    s_waitcnt lgkmcnt(2)
    v_mfma_f32_16x16x32_bf16 v[8:11], v[68:71], v[104:107], v[8:11]
    v_mfma_f32_16x16x32_bf16 v[28:31], v[68:71], v[108:111], v[28:31]
    v_mfma_f32_16x16x32_bf16 v[12:15], v[72:75], v[104:107], v[12:15]
    v_mfma_f32_16x16x32_bf16 v[32:35], v[72:75], v[108:111], v[32:35]
    s_waitcnt lgkmcnt(0)
    v_mfma_f32_16x16x32_bf16 v[16:19], v[76:79], v[104:107], v[16:19]
    v_mfma_f32_16x16x32_bf16 v[36:39], v[76:79], v[108:111], v[36:39]
    buffer_load_dwordx4 v[128:131], v165, s[56:59], s4 offen offset:0 sc1
    buffer_load_dwordx4 v[132:135], v153, s[56:59], s4 offen offset:0 sc1
    buffer_load_dwordx4 v[136:139], v165, s[56:59], s4 offen offset:2048 sc1
    buffer_load_dwordx4 v[140:143], v153, s[56:59], s4 offen offset:2048 sc1
    s_add_u32 s4, s4, 12288
    s_waitcnt vmcnt(8)
    s_barrier
    s_mul_i32 s3, s14, 20480
    s_add_u32 s3, s3, 40960
    v_add_u32 v161, s3, v163
    v_add_u32 v162, s3, v164
    s_waitcnt vmcnt(0)
    ds_read_b64_tr_b16 v[40:41], v161 offset:0
    ds_read_b64_tr_b16 v[42:43], v162 offset:0
    ds_read_b64_tr_b16 v[44:45], v161 offset:8
    ds_read_b64_tr_b16 v[46:47], v162 offset:8
    ds_read_b64_tr_b16 v[48:49], v161 offset:16
    ds_read_b64_tr_b16 v[50:51], v162 offset:16
    ds_read_b64_tr_b16 v[52:53], v161 offset:24
    ds_read_b64_tr_b16 v[54:55], v162 offset:24
    ds_read_b64_tr_b16 v[56:57], v161 offset:32
    ds_read_b64_tr_b16 v[58:59], v162 offset:32
    s_waitcnt lgkmcnt(6)
    v_mfma_f32_16x16x32_bf16 v[0:3], v[40:43], v[112:115], v[0:3]
    ds_read_b64_tr_b16 v[60:61], v161 offset:5120
    v_mfma_f32_16x16x32_bf16 v[20:23], v[40:43], v[116:119], v[20:23]
    ds_read_b64_tr_b16 v[62:63], v162 offset:5120
    v_mfma_f32_16x16x32_bf16 v[4:7], v[44:47], v[112:115], v[4:7]
    ds_read_b64_tr_b16 v[64:65], v161 offset:5128
    v_mfma_f32_16x16x32_bf16 v[24:27], v[44:47], v[116:119], v[24:27]
    ds_read_b64_tr_b16 v[66:67], v162 offset:5128
    s_waitcnt lgkmcnt(6)
    v_mfma_f32_16x16x32_bf16 v[8:11], v[48:51], v[112:115], v[8:11]
    ds_read_b64_tr_b16 v[68:69], v161 offset:5136
    v_mfma_f32_16x16x32_bf16 v[28:31], v[48:51], v[116:119], v[28:31]
    ds_read_b64_tr_b16 v[70:71], v162 offset:5136
    v_mfma_f32_16x16x32_bf16 v[12:15], v[52:55], v[112:115], v[12:15]
    ds_read_b64_tr_b16 v[72:73], v161 offset:5144
    v_mfma_f32_16x16x32_bf16 v[32:35], v[52:55], v[116:119], v[32:35]
    ds_read_b64_tr_b16 v[74:75], v162 offset:5144
    s_waitcnt lgkmcnt(8)
    v_mfma_f32_16x16x32_bf16 v[16:19], v[56:59], v[112:115], v[16:19]
    ds_read_b64_tr_b16 v[76:77], v161 offset:5152
    v_mfma_f32_16x16x32_bf16 v[36:39], v[56:59], v[116:119], v[36:39]
    ds_read_b64_tr_b16 v[78:79], v162 offset:5152
    s_mov_b32 s15, 135168
    s_add_u32 m0, s17, 0
    s_sub_u32 s21, s90, s17
    buffer_load_dwordx4 v166, s[28:31], s15 offen offset:0 sc1 lds
    buffer_load_dwordx4 v166, s[28:31], s15 offen offset:1024 sc1 lds
    s_add_u32 m0, s91, 0
    s_add_u32 s21, s21, s15
    buffer_load_dwordx4 v150, s[28:31], s15 offen offset:0 sc1 lds
    buffer_load_dwordx4 v151, s[28:31], s15 offen offset:1024 sc1 lds
    buffer_load_dwordx4 v152, s[28:31], s15 offen offset:2048 sc1 lds
    s_add_u32 m0, s90, 0
    s_mov_b32 exec_hi, 0
    buffer_load_dwordx4 v166, s[28:31], s21 offen sc1 lds
    s_mov_b64 exec, -1
    s_add_u32 m0, s6, 77824
    s_nop 0
    buffer_load_dwordx4 v144, s[36:39], s7 offen lds
    s_add_u32 m0, s6, 78848
    s_nop 0
    buffer_load_dwordx4 v145, s[36:39], s7 offen lds
    s_add_u32 m0, s6, 79872
    s_nop 0
    buffer_load_dwordx4 v146, s[36:39], s7 offen lds
    s_add_u32 m0, s6, 80896
    s_nop 0
    buffer_load_dwordx4 v147, s[36:39], s7 offen lds
    s_waitcnt lgkmcnt(6)
    v_mfma_f32_16x16x32_bf16 v[0:3], v[60:63], v[120:123], v[0:3]
    ds_read_b64_tr_b16 v[40:41], v161 offset:10240
    v_mfma_f32_16x16x32_bf16 v[20:23], v[60:63], v[124:127], v[20:23]
    ds_read_b64_tr_b16 v[42:43], v162 offset:10240
    v_mfma_f32_16x16x32_bf16 v[4:7], v[64:67], v[120:123], v[4:7]
    ds_read_b64_tr_b16 v[44:45], v161 offset:10248
    v_mfma_f32_16x16x32_bf16 v[24:27], v[64:67], v[124:127], v[24:27]
    ds_read_b64_tr_b16 v[46:47], v162 offset:10248
    s_waitcnt lgkmcnt(6)
    v_mfma_f32_16x16x32_bf16 v[8:11], v[68:71], v[120:123], v[8:11]
    ds_read_b64_tr_b16 v[48:49], v161 offset:10256
    v_mfma_f32_16x16x32_bf16 v[28:31], v[68:71], v[124:127], v[28:31]
    ds_read_b64_tr_b16 v[50:51], v162 offset:10256
    v_mfma_f32_16x16x32_bf16 v[12:15], v[72:75], v[120:123], v[12:15]
    ds_read_b64_tr_b16 v[52:53], v161 offset:10264
    v_mfma_f32_16x16x32_bf16 v[32:35], v[72:75], v[124:127], v[32:35]
    ds_read_b64_tr_b16 v[54:55], v162 offset:10264
    s_waitcnt lgkmcnt(8)
    v_mfma_f32_16x16x32_bf16 v[16:19], v[76:79], v[120:123], v[16:19]
    ds_read_b64_tr_b16 v[56:57], v161 offset:10272
    v_mfma_f32_16x16x32_bf16 v[36:39], v[76:79], v[124:127], v[36:39]
    ds_read_b64_tr_b16 v[58:59], v162 offset:10272
    s_add_u32 m0, s6, 81920
    s_nop 0
    buffer_load_dwordx4 v148, s[36:39], s7 offen lds
    s_add_u32 s7, s7, 40960
    s_add_u32 m0, s6, 82944
    s_nop 0
    buffer_load_dwordx4 v144, s[36:39], s7 offen lds
    s_add_u32 m0, s6, 83968
    s_nop 0
    buffer_load_dwordx4 v145, s[36:39], s7 offen lds
    s_add_u32 m0, s6, 84992
    s_nop 0
    buffer_load_dwordx4 v146, s[36:39], s7 offen lds
    s_add_u32 m0, s6, 86016
    s_nop 0
    buffer_load_dwordx4 v147, s[36:39], s7 offen lds
    s_waitcnt lgkmcnt(6)
    v_mfma_f32_16x16x32_bf16 v[0:3], v[40:43], v[128:131], v[0:3]
    ds_read_b64_tr_b16 v[60:61], v161 offset:15360
    v_mfma_f32_16x16x32_bf16 v[20:23], v[40:43], v[132:135], v[20:23]
    ds_read_b64_tr_b16 v[62:63], v162 offset:15360
    v_mfma_f32_16x16x32_bf16 v[4:7], v[44:47], v[128:131], v[4:7]
    ds_read_b64_tr_b16 v[64:65], v161 offset:15368
    v_mfma_f32_16x16x32_bf16 v[24:27], v[44:47], v[132:135], v[24:27]
    ds_read_b64_tr_b16 v[66:67], v162 offset:15368
    s_waitcnt lgkmcnt(6)
    v_mfma_f32_16x16x32_bf16 v[8:11], v[48:51], v[128:131], v[8:11]
    ds_read_b64_tr_b16 v[68:69], v161 offset:15376
    v_mfma_f32_16x16x32_bf16 v[28:31], v[48:51], v[132:135], v[28:31]
    ds_read_b64_tr_b16 v[70:71], v162 offset:15376
    v_mfma_f32_16x16x32_bf16 v[12:15], v[52:55], v[128:131], v[12:15]
    ds_read_b64_tr_b16 v[72:73], v161 offset:15384
    v_mfma_f32_16x16x32_bf16 v[32:35], v[52:55], v[132:135], v[32:35]
    ds_read_b64_tr_b16 v[74:75], v162 offset:15384
    s_waitcnt lgkmcnt(8)
    v_mfma_f32_16x16x32_bf16 v[16:19], v[56:59], v[128:131], v[16:19]
    ds_read_b64_tr_b16 v[76:77], v161 offset:15392
    v_mfma_f32_16x16x32_bf16 v[36:39], v[56:59], v[132:135], v[36:39]
    ds_read_b64_tr_b16 v[78:79], v162 offset:15392
    s_add_u32 m0, s6, 87040
    s_nop 0
    buffer_load_dwordx4 v148, s[36:39], s7 offen lds
    s_add_u32 s7, s7, 286720
    buffer_load_dwordx4 v[80:83], v165, s[56:59], s4 offen offset:0 sc1
    buffer_load_dwordx4 v[84:87], v153, s[56:59], s4 offen offset:0 sc1
    buffer_load_dwordx4 v[88:91], v165, s[56:59], s4 offen offset:2048 sc1
    buffer_load_dwordx4 v[92:95], v153, s[56:59], s4 offen offset:2048 sc1
    s_add_u32 s4, s4, 4096
    s_waitcnt lgkmcnt(6)
    v_mfma_f32_16x16x32_bf16 v[0:3], v[60:63], v[136:139], v[0:3]
    v_mfma_f32_16x16x32_bf16 v[20:23], v[60:63], v[140:143], v[20:23]
    v_mfma_f32_16x16x32_bf16 v[4:7], v[64:67], v[136:139], v[4:7]
    v_mfma_f32_16x16x32_bf16 v[24:27], v[64:67], v[140:143], v[24:27]
    s_waitcnt lgkmcnt(2)
    v_mfma_f32_16x16x32_bf16 v[8:11], v[68:71], v[136:139], v[8:11]
    v_mfma_f32_16x16x32_bf16 v[28:31], v[68:71], v[140:143], v[28:31]
    v_mfma_f32_16x16x32_bf16 v[12:15], v[72:75], v[136:139], v[12:15]
    v_mfma_f32_16x16x32_bf16 v[32:35], v[72:75], v[140:143], v[32:35]
    s_waitcnt lgkmcnt(0)
    v_mfma_f32_16x16x32_bf16 v[16:19], v[76:79], v[136:139], v[16:19]
    v_mfma_f32_16x16x32_bf16 v[36:39], v[76:79], v[140:143], v[36:39]
    buffer_load_dwordx4 v[96:99], v165, s[56:59], s4 offen offset:0 sc1
    buffer_load_dwordx4 v[100:103], v153, s[56:59], s4 offen offset:0 sc1
    buffer_load_dwordx4 v[104:107], v165, s[56:59], s4 offen offset:2048 sc1
    buffer_load_dwordx4 v[108:111], v153, s[56:59], s4 offen offset:2048 sc1
    s_add_u32 s4, s4, 12288
    s_waitcnt vmcnt(8)
    s_barrier
    s_mov_b32 s3, 524288
L_poll2b:
    buffer_load_dword v159, v149, s[56:59], 0 offen sc1
    s_sub_u32 s3, s3, 1
    s_cmp_eq_u32 s3, 0
    s_cbranch_scc1 L_poll2b_ok
    s_waitcnt vmcnt(0)
    v_cmp_ne_u32 vcc, s60, v159
    s_nop 4
    s_cbranch_vccz L_poll2b_ok
    s_sleep 8
    s_branch L_poll2b
L_poll2b_ok:
    s_mul_i32 s3, s14, 20480
    s_add_u32 s3, s3, 0
    v_add_u32 v161, s3, v163
    v_add_u32 v162, s3, v164
    ds_read_b64_tr_b16 v[40:41], v161 offset:0
    ds_read_b64_tr_b16 v[42:43], v162 offset:0
    ds_read_b64_tr_b16 v[44:45], v161 offset:8
    ds_read_b64_tr_b16 v[46:47], v162 offset:8
    ds_read_b64_tr_b16 v[48:49], v161 offset:16
    ds_read_b64_tr_b16 v[50:51], v162 offset:16
    ds_read_b64_tr_b16 v[52:53], v161 offset:24
    ds_read_b64_tr_b16 v[54:55], v162 offset:24
    ds_read_b64_tr_b16 v[56:57], v161 offset:32
    ds_read_b64_tr_b16 v[58:59], v162 offset:32
    s_waitcnt lgkmcnt(6)
    v_mfma_f32_16x16x32_bf16 v[0:3], v[40:43], v[80:83], v[0:3]
    ds_read_b64_tr_b16 v[60:61], v161 offset:5120
    v_mfma_f32_16x16x32_bf16 v[20:23], v[40:43], v[84:87], v[20:23]
    ds_read_b64_tr_b16 v[62:63], v162 offset:5120
    v_mfma_f32_16x16x32_bf16 v[4:7], v[44:47], v[80:83], v[4:7]
    ds_read_b64_tr_b16 v[64:65], v161 offset:5128
    v_mfma_f32_16x16x32_bf16 v[24:27], v[44:47], v[84:87], v[24:27]
    ds_read_b64_tr_b16 v[66:67], v162 offset:5128
    s_waitcnt lgkmcnt(6)
    v_mfma_f32_16x16x32_bf16 v[8:11], v[48:51], v[80:83], v[8:11]
    ds_read_b64_tr_b16 v[68:69], v161 offset:5136
    v_mfma_f32_16x16x32_bf16 v[28:31], v[48:51], v[84:87], v[28:31]
    ds_read_b64_tr_b16 v[70:71], v162 offset:5136
    v_mfma_f32_16x16x32_bf16 v[12:15], v[52:55], v[80:83], v[12:15]
    ds_read_b64_tr_b16 v[72:73], v161 offset:5144
    v_mfma_f32_16x16x32_bf16 v[32:35], v[52:55], v[84:87], v[32:35]
    ds_read_b64_tr_b16 v[74:75], v162 offset:5144
    s_waitcnt lgkmcnt(8)
    v_mfma_f32_16x16x32_bf16 v[16:19], v[56:59], v[80:83], v[16:19]
    ds_read_b64_tr_b16 v[76:77], v161 offset:5152
    v_mfma_f32_16x16x32_bf16 v[36:39], v[56:59], v[84:87], v[36:39]
    ds_read_b64_tr_b16 v[78:79], v162 offset:5152
    s_mov_b32 s15, 157696
    s_add_u32 m0, s17, 32768
    s_sub_u32 s21, s90, s17
    buffer_load_dwordx4 v166, s[28:31], s15 offen offset:0 sc1 lds
    buffer_load_dwordx4 v166, s[28:31], s15 offen offset:1024 sc1 lds
    s_add_u32 m0, s91, 32768
    s_add_u32 s21, s21, s15
    buffer_load_dwordx4 v150, s[28:31], s15 offen offset:0 sc1 lds
    buffer_load_dwordx4 v151, s[28:31], s15 offen offset:1024 sc1 lds
    buffer_load_dwordx4 v152, s[28:31], s15 offen offset:2048 sc1 lds
    s_add_u32 m0, s90, 32768
    s_mov_b32 exec_hi, 0
    buffer_load_dwordx4 v166, s[28:31], s21 offen sc1 lds
    s_mov_b64 exec, -1
    s_add_u32 m0, s6, 118784
    s_nop 0
    buffer_load_dwordx4 v144, s[36:39], s7 offen lds
    s_add_u32 m0, s6, 119808
    s_nop 0
    buffer_load_dwordx4 v145, s[36:39], s7 offen lds
    s_add_u32 m0, s6, 120832
    s_nop 0
    buffer_load_dwordx4 v146, s[36:39], s7 offen lds
    s_add_u32 m0, s6, 121856
    s_nop 0
    buffer_load_dwordx4 v147, s[36:39], s7 offen lds
    s_waitcnt lgkmcnt(6)
    v_mfma_f32_16x16x32_bf16 v[0:3], v[60:63], v[88:91], v[0:3]
    ds_read_b64_tr_b16 v[40:41], v161 offset:10240
    v_mfma_f32_16x16x32_bf16 v[20:23], v[60:63], v[92:95], v[20:23]
    ds_read_b64_tr_b16 v[42:43], v162 offset:10240
    v_mfma_f32_16x16x32_bf16 v[4:7], v[64:67], v[88:91], v[4:7]
    ds_read_b64_tr_b16 v[44:45], v161 offset:10248
    v_mfma_f32_16x16x32_bf16 v[24:27], v[64:67], v[92:95], v[24:27]
    ds_read_b64_tr_b16 v[46:47], v162 offset:10248
    s_waitcnt lgkmcnt(6)
    v_mfma_f32_16x16x32_bf16 v[8:11], v[68:71], v[88:91], v[8:11]
    ds_read_b64_tr_b16 v[48:49], v161 offset:10256
    v_mfma_f32_16x16x32_bf16 v[28:31], v[68:71], v[92:95], v[28:31]
    ds_read_b64_tr_b16 v[50:51], v162 offset:10256
    v_mfma_f32_16x16x32_bf16 v[12:15], v[72:75], v[88:91], v[12:15]
    ds_read_b64_tr_b16 v[52:53], v161 offset:10264
    v_mfma_f32_16x16x32_bf16 v[32:35], v[72:75], v[92:95], v[32:35]
    ds_read_b64_tr_b16 v[54:55], v162 offset:10264
    s_waitcnt lgkmcnt(8)
    v_mfma_f32_16x16x32_bf16 v[16:19], v[76:79], v[88:91], v[16:19]
    ds_read_b64_tr_b16 v[56:57], v161 offset:10272
    v_mfma_f32_16x16x32_bf16 v[36:39], v[76:79], v[92:95], v[36:39]
    ds_read_b64_tr_b16 v[58:59], v162 offset:10272
    s_add_u32 m0, s6, 122880
    s_nop 0
    buffer_load_dwordx4 v148, s[36:39], s7 offen lds
    s_add_u32 s7, s7, 40960
    s_add_u32 m0, s6, 123904
    s_nop 0
    buffer_load_dwordx4 v144, s[36:39], s7 offen lds
    s_add_u32 m0, s6, 124928
    s_nop 0
    buffer_load_dwordx4 v145, s[36:39], s7 offen lds
    s_add_u32 m0, s6, 125952
    s_nop 0
    buffer_load_dwordx4 v146, s[36:39], s7 offen lds
    s_add_u32 m0, s6, 126976
    s_nop 0
    buffer_load_dwordx4 v147, s[36:39], s7 offen lds
    s_waitcnt lgkmcnt(6)
    v_mfma_f32_16x16x32_bf16 v[0:3], v[40:43], v[96:99], v[0:3]
    ds_read_b64_tr_b16 v[60:61], v161 offset:15360
    v_mfma_f32_16x16x32_bf16 v[20:23], v[40:43], v[100:103], v[20:23]
    ds_read_b64_tr_b16 v[62:63], v162 offset:15360
    v_mfma_f32_16x16x32_bf16 v[4:7], v[44:47], v[96:99], v[4:7]
    ds_read_b64_tr_b16 v[64:65], v161 offset:15368
    v_mfma_f32_16x16x32_bf16 v[24:27], v[44:47], v[100:103], v[24:27]
    ds_read_b64_tr_b16 v[66:67], v162 offset:15368
    s_waitcnt lgkmcnt(6)
    v_mfma_f32_16x16x32_bf16 v[8:11], v[48:51], v[96:99], v[8:11]
    ds_read_b64_tr_b16 v[68:69], v161 offset:15376
    v_mfma_f32_16x16x32_bf16 v[28:31], v[48:51], v[100:103], v[28:31]
    ds_read_b64_tr_b16 v[70:71], v162 offset:15376
    v_mfma_f32_16x16x32_bf16 v[12:15], v[52:55], v[96:99], v[12:15]
    ds_read_b64_tr_b16 v[72:73], v161 offset:15384
    v_mfma_f32_16x16x32_bf16 v[32:35], v[52:55], v[100:103], v[32:35]
    ds_read_b64_tr_b16 v[74:75], v162 offset:15384
    s_waitcnt lgkmcnt(8)
    v_mfma_f32_16x16x32_bf16 v[16:19], v[56:59], v[96:99], v[16:19]
    ds_read_b64_tr_b16 v[76:77], v161 offset:15392
    v_mfma_f32_16x16x32_bf16 v[36:39], v[56:59], v[100:103], v[36:39]
    ds_read_b64_tr_b16 v[78:79], v162 offset:15392
    s_add_u32 m0, s6, 128000
    s_nop 0
    buffer_load_dwordx4 v148, s[36:39], s7 offen lds
    s_add_u32 s7, s7, 286720
    buffer_load_dwordx4 v[112:115], v165, s[56:59], s4 offen offset:0 sc1
    buffer_load_dwordx4 v[116:119], v153, s[56:59], s4 offen offset:0 sc1
    buffer_load_dwordx4 v[120:123], v165, s[56:59], s4 offen offset:2048 sc1
    buffer_load_dwordx4 v[124:127], v153, s[56:59], s4 offen offset:2048 sc1
    s_add_u32 s4, s4, 4096
    s_waitcnt lgkmcnt(6)
    v_mfma_f32_16x16x32_bf16 v[0:3], v[60:63], v[104:107], v[0:3]
    v_mfma_f32_16x16x32_bf16 v[20:23], v[60:63], v[108:111], v[20:23]
    v_mfma_f32_16x16x32_bf16 v[4:7], v[64:67], v[104:107], v[4:7]
    v_mfma_f32_16x16x32_bf16 v[24:27], v[64:67], v[108:111], v[24:27]
    s_waitcnt lgkmcnt(2)
    v_mfma_f32_16x16x32_bf16 v[8:11], v[68:71], v[104:107], v[8:11]
    v_mfma_f32_16x16x32_bf16 v[28:31], v[68:71], v[108:111], v[28:31]
    v_mfma_f32_16x16x32_bf16 v[12:15], v[72:75], v[104:107], v[12:15]
    v_mfma_f32_16x16x32_bf16 v[32:35], v[72:75], v[108:111], v[32:35]
    s_waitcnt lgkmcnt(0)
    v_mfma_f32_16x16x32_bf16 v[16:19], v[76:79], v[104:107], v[16:19]
    v_mfma_f32_16x16x32_bf16 v[36:39], v[76:79], v[108:111], v[36:39]
    buffer_load_dwordx4 v[128:131], v165, s[56:59], s4 offen offset:0 sc1
    buffer_load_dwordx4 v[132:135], v153, s[56:59], s4 offen offset:0 sc1
    buffer_load_dwordx4 v[136:139], v165, s[56:59], s4 offen offset:2048 sc1
    buffer_load_dwordx4 v[140:143], v153, s[56:59], s4 offen offset:2048 sc1
    s_add_u32 s4, s4, 12288
    s_waitcnt vmcnt(8)
    s_barrier
    s_mov_b32 s3, 0x1999999a
    s_mul_i32 s95, s63, 160
    v_add_u32 v154, 0, v167
    v_mul_hi_u32 v155, v154, s3
    v_mul_u32_u24 v156, 10, v155
    v_sub_u32 v154, v154, v156
    v_lshrrev_b32 v156, 1, v155
    v_and_b32 v156, 4, v156
    v_xor_b32 v155, v155, v156
    v_lshrrev_b32 v156, 4, v155
    v_lshl_add_u32 v155, v156, 3, v155
    v_mul_u32_u24 v155, 1280, v155
    v_lshl_add_u32 v154, v154, 4, v155
    v_add_u32 v144, s95, v154
    v_add_u32 v154, 64, v167
    v_mul_hi_u32 v155, v154, s3
    v_mul_u32_u24 v156, 10, v155
    v_sub_u32 v154, v154, v156
    v_lshrrev_b32 v156, 1, v155
    v_and_b32 v156, 4, v156
    v_xor_b32 v155, v155, v156
    v_lshrrev_b32 v156, 4, v155
    v_lshl_add_u32 v155, v156, 3, v155
    v_mul_u32_u24 v155, 1280, v155
    v_lshl_add_u32 v154, v154, 4, v155
    v_add_u32 v145, s95, v154
    v_add_u32 v154, 128, v167
    v_mul_hi_u32 v155, v154, s3
    v_mul_u32_u24 v156, 10, v155
    v_sub_u32 v154, v154, v156
    v_lshrrev_b32 v156, 1, v155
    v_and_b32 v156, 4, v156
    v_xor_b32 v155, v155, v156
    v_lshrrev_b32 v156, 4, v155
    v_lshl_add_u32 v155, v156, 3, v155
    v_mul_u32_u24 v155, 1280, v155
    v_lshl_add_u32 v154, v154, 4, v155
    v_add_u32 v146, s95, v154
    v_add_u32 v154, 192, v167
    v_mul_hi_u32 v155, v154, s3
    v_mul_u32_u24 v156, 10, v155
    v_sub_u32 v154, v154, v156
    v_lshrrev_b32 v156, 1, v155
    v_and_b32 v156, 4, v156
    v_xor_b32 v155, v155, v156
    v_lshrrev_b32 v156, 4, v155
    v_lshl_add_u32 v155, v156, 3, v155
    v_mul_u32_u24 v155, 1280, v155
    v_lshl_add_u32 v154, v154, 4, v155
    v_add_u32 v147, s95, v154
    v_add_u32 v154, 256, v167
    v_mul_hi_u32 v155, v154, s3
    v_mul_u32_u24 v156, 10, v155
    v_sub_u32 v154, v154, v156
    v_lshrrev_b32 v156, 1, v155
    v_and_b32 v156, 4, v156
    v_xor_b32 v155, v155, v156
    v_lshrrev_b32 v156, 4, v155
    v_lshl_add_u32 v155, v156, 3, v155
    v_mul_u32_u24 v155, 1280, v155
    v_lshl_add_u32 v154, v154, 4, v155
    v_add_u32 v148, s95, v154
    s_mul_i32 s11, s61, 102400
    s_mul_i32 s3, s14, 20480
    s_add_u32 s3, s3, 40960
    v_add_u32 v161, s3, v163
    v_add_u32 v162, s3, v164
    s_waitcnt vmcnt(0)
    ds_read_b64_tr_b16 v[40:41], v161 offset:0
    ds_read_b64_tr_b16 v[42:43], v162 offset:0
    ds_read_b64_tr_b16 v[44:45], v161 offset:8
    ds_read_b64_tr_b16 v[46:47], v162 offset:8
    ds_read_b64_tr_b16 v[48:49], v161 offset:16
    ds_read_b64_tr_b16 v[50:51], v162 offset:16
    ds_read_b64_tr_b16 v[52:53], v161 offset:24
    ds_read_b64_tr_b16 v[54:55], v162 offset:24
    ds_read_b64_tr_b16 v[56:57], v161 offset:32
    ds_read_b64_tr_b16 v[58:59], v162 offset:32
    s_waitcnt lgkmcnt(6)
    v_mfma_f32_16x16x32_bf16 v[0:3], v[40:43], v[112:115], v[0:3]
    ds_read_b64_tr_b16 v[60:61], v161 offset:5120
    v_mfma_f32_16x16x32_bf16 v[20:23], v[40:43], v[116:119], v[20:23]
    ds_read_b64_tr_b16 v[62:63], v162 offset:5120
    v_mfma_f32_16x16x32_bf16 v[4:7], v[44:47], v[112:115], v[4:7]
    ds_read_b64_tr_b16 v[64:65], v161 offset:5128
    v_mfma_f32_16x16x32_bf16 v[24:27], v[44:47], v[116:119], v[24:27]
    ds_read_b64_tr_b16 v[66:67], v162 offset:5128
    s_waitcnt lgkmcnt(6)
    v_mfma_f32_16x16x32_bf16 v[8:11], v[48:51], v[112:115], v[8:11]
    ds_read_b64_tr_b16 v[68:69], v161 offset:5136
    v_mfma_f32_16x16x32_bf16 v[28:31], v[48:51], v[116:119], v[28:31]
    ds_read_b64_tr_b16 v[70:71], v162 offset:5136
    v_mfma_f32_16x16x32_bf16 v[12:15], v[52:55], v[112:115], v[12:15]
    ds_read_b64_tr_b16 v[72:73], v161 offset:5144
    v_mfma_f32_16x16x32_bf16 v[32:35], v[52:55], v[116:119], v[32:35]
    ds_read_b64_tr_b16 v[74:75], v162 offset:5144
    s_waitcnt lgkmcnt(8)
    v_mfma_f32_16x16x32_bf16 v[16:19], v[56:59], v[112:115], v[16:19]
    ds_read_b64_tr_b16 v[76:77], v161 offset:5152
    v_mfma_f32_16x16x32_bf16 v[36:39], v[56:59], v[116:119], v[36:39]
    ds_read_b64_tr_b16 v[78:79], v162 offset:5152
    s_add_u32 s7, s11, 0
    s_add_u32 m0, s6, 77824
    s_nop 0
    buffer_load_dwordx4 v144, s[48:51], s7 offen lds
    s_add_u32 m0, s6, 78848
    s_nop 0
    buffer_load_dwordx4 v145, s[48:51], s7 offen lds
    s_add_u32 m0, s6, 79872
    s_nop 0
    buffer_load_dwordx4 v146, s[48:51], s7 offen lds
    s_waitcnt lgkmcnt(6)
    v_mfma_f32_16x16x32_bf16 v[0:3], v[60:63], v[120:123], v[0:3]
    ds_read_b64_tr_b16 v[40:41], v161 offset:10240
    v_mfma_f32_16x16x32_bf16 v[20:23], v[60:63], v[124:127], v[20:23]
    ds_read_b64_tr_b16 v[42:43], v162 offset:10240
    v_mfma_f32_16x16x32_bf16 v[4:7], v[64:67], v[120:123], v[4:7]
    ds_read_b64_tr_b16 v[44:45], v161 offset:10248
    v_mfma_f32_16x16x32_bf16 v[24:27], v[64:67], v[124:127], v[24:27]
    ds_read_b64_tr_b16 v[46:47], v162 offset:10248
    s_waitcnt lgkmcnt(6)
    v_mfma_f32_16x16x32_bf16 v[8:11], v[68:71], v[120:123], v[8:11]
    ds_read_b64_tr_b16 v[48:49], v161 offset:10256
    v_mfma_f32_16x16x32_bf16 v[28:31], v[68:71], v[124:127], v[28:31]
    ds_read_b64_tr_b16 v[50:51], v162 offset:10256
    v_mfma_f32_16x16x32_bf16 v[12:15], v[72:75], v[120:123], v[12:15]
    ds_read_b64_tr_b16 v[52:53], v161 offset:10264
    v_mfma_f32_16x16x32_bf16 v[32:35], v[72:75], v[124:127], v[32:35]
    ds_read_b64_tr_b16 v[54:55], v162 offset:10264
    s_waitcnt lgkmcnt(8)
    v_mfma_f32_16x16x32_bf16 v[16:19], v[76:79], v[120:123], v[16:19]
    ds_read_b64_tr_b16 v[56:57], v161 offset:10272
    v_mfma_f32_16x16x32_bf16 v[36:39], v[76:79], v[124:127], v[36:39]
    ds_read_b64_tr_b16 v[58:59], v162 offset:10272
    s_add_u32 m0, s6, 80896
    s_nop 0
    buffer_load_dwordx4 v147, s[48:51], s7 offen lds
    s_add_u32 m0, s6, 81920
    s_nop 0
    buffer_load_dwordx4 v148, s[48:51], s7 offen lds
    s_add_u32 s7, s11, 51200
    s_add_u32 m0, s6, 82944
    s_nop 0
    buffer_load_dwordx4 v144, s[48:51], s7 offen lds
    s_waitcnt lgkmcnt(6)
    v_mfma_f32_16x16x32_bf16 v[0:3], v[40:43], v[128:131], v[0:3]
    ds_read_b64_tr_b16 v[60:61], v161 offset:15360
    v_mfma_f32_16x16x32_bf16 v[20:23], v[40:43], v[132:135], v[20:23]
    ds_read_b64_tr_b16 v[62:63], v162 offset:15360
    v_mfma_f32_16x16x32_bf16 v[4:7], v[44:47], v[128:131], v[4:7]
    ds_read_b64_tr_b16 v[64:65], v161 offset:15368
    v_mfma_f32_16x16x32_bf16 v[24:27], v[44:47], v[132:135], v[24:27]
    ds_read_b64_tr_b16 v[66:67], v162 offset:15368
    s_waitcnt lgkmcnt(6)
    v_mfma_f32_16x16x32_bf16 v[8:11], v[48:51], v[128:131], v[8:11]
    ds_read_b64_tr_b16 v[68:69], v161 offset:15376
    v_mfma_f32_16x16x32_bf16 v[28:31], v[48:51], v[132:135], v[28:31]
    ds_read_b64_tr_b16 v[70:71], v162 offset:15376
    v_mfma_f32_16x16x32_bf16 v[12:15], v[52:55], v[128:131], v[12:15]
    ds_read_b64_tr_b16 v[72:73], v161 offset:15384
    v_mfma_f32_16x16x32_bf16 v[32:35], v[52:55], v[132:135], v[32:35]
    ds_read_b64_tr_b16 v[74:75], v162 offset:15384
    s_waitcnt lgkmcnt(8)
    v_mfma_f32_16x16x32_bf16 v[16:19], v[56:59], v[128:131], v[16:19]
    ds_read_b64_tr_b16 v[76:77], v161 offset:15392
    v_mfma_f32_16x16x32_bf16 v[36:39], v[56:59], v[132:135], v[36:39]
    ds_read_b64_tr_b16 v[78:79], v162 offset:15392
    s_add_u32 m0, s6, 83968
    s_nop 0
    buffer_load_dwordx4 v145, s[48:51], s7 offen lds
    s_add_u32 m0, s6, 84992
    s_nop 0
    buffer_load_dwordx4 v146, s[48:51], s7 offen lds
    s_add_u32 m0, s6, 86016
    s_nop 0
    buffer_load_dwordx4 v147, s[48:51], s7 offen lds
    s_waitcnt lgkmcnt(6)
    v_mfma_f32_16x16x32_bf16 v[0:3], v[60:63], v[136:139], v[0:3]
    v_mfma_f32_16x16x32_bf16 v[20:23], v[60:63], v[140:143], v[20:23]
    v_mfma_f32_16x16x32_bf16 v[4:7], v[64:67], v[136:139], v[4:7]
    v_mfma_f32_16x16x32_bf16 v[24:27], v[64:67], v[140:143], v[24:27]
    s_waitcnt lgkmcnt(2)
    v_mfma_f32_16x16x32_bf16 v[8:11], v[68:71], v[136:139], v[8:11]
    v_mfma_f32_16x16x32_bf16 v[28:31], v[68:71], v[140:143], v[28:31]
    v_mfma_f32_16x16x32_bf16 v[12:15], v[72:75], v[136:139], v[12:15]
    v_mfma_f32_16x16x32_bf16 v[32:35], v[72:75], v[140:143], v[32:35]
    s_waitcnt lgkmcnt(0)
    v_mfma_f32_16x16x32_bf16 v[16:19], v[76:79], v[136:139], v[16:19]
    v_mfma_f32_16x16x32_bf16 v[36:39], v[76:79], v[140:143], v[36:39]
    s_add_u32 m0, s6, 87040
    s_nop 0
    buffer_load_dwordx4 v148, s[48:51], s7 offen lds
    s_mul_i32 s11, s61, 204800
    s_mul_i32 s6, s61, 5120
    s_mov_b32 s3, 0x1999999a
    s_mul_i32 s95, s63, 160
    v_add_u32 v154, 0, v167
    v_mul_hi_u32 v155, v154, s3
    v_mul_u32_u24 v156, 10, v155
    v_sub_u32 v154, v154, v156
    v_lshrrev_b32 v156, 1, v155
    v_and_b32 v156, 4, v156
    v_xor_b32 v155, v155, v156
    v_lshrrev_b32 v156, 3, v155
    v_lshl_add_u32 v155, v156, 5, v155
    v_add_u32 v155, 16, v155
    v_mul_u32_u24 v155, 1280, v155
    v_lshl_add_u32 v154, v154, 4, v155
    v_add_u32 v80, s95, v154
    v_add_u32 v154, 64, v167
    v_mul_hi_u32 v155, v154, s3
    v_mul_u32_u24 v156, 10, v155
    v_sub_u32 v154, v154, v156
    v_lshrrev_b32 v156, 1, v155
    v_and_b32 v156, 4, v156
    v_xor_b32 v155, v155, v156
    v_lshrrev_b32 v156, 3, v155
    v_lshl_add_u32 v155, v156, 5, v155
    v_add_u32 v155, 16, v155
    v_mul_u32_u24 v155, 1280, v155
    v_lshl_add_u32 v154, v154, 4, v155
    v_add_u32 v81, s95, v154
    v_add_u32 v154, 128, v167
    v_mul_hi_u32 v155, v154, s3
    v_mul_u32_u24 v156, 10, v155
    v_sub_u32 v154, v154, v156
    v_lshrrev_b32 v156, 1, v155
    v_and_b32 v156, 4, v156
    v_xor_b32 v155, v155, v156
    v_lshrrev_b32 v156, 3, v155
    v_lshl_add_u32 v155, v156, 5, v155
    v_add_u32 v155, 16, v155
    v_mul_u32_u24 v155, 1280, v155
    v_lshl_add_u32 v154, v154, 4, v155
    v_add_u32 v82, s95, v154
    v_add_u32 v154, 192, v167
    v_mul_hi_u32 v155, v154, s3
    v_mul_u32_u24 v156, 10, v155
    v_sub_u32 v154, v154, v156
    v_lshrrev_b32 v156, 1, v155
    v_and_b32 v156, 4, v156
    v_xor_b32 v155, v155, v156
    v_lshrrev_b32 v156, 3, v155
    v_lshl_add_u32 v155, v156, 5, v155
    v_add_u32 v155, 16, v155
    v_mul_u32_u24 v155, 1280, v155
    v_lshl_add_u32 v154, v154, 4, v155
    v_add_u32 v83, s95, v154
    v_add_u32 v154, 256, v167
    v_mul_hi_u32 v155, v154, s3
    v_mul_u32_u24 v156, 10, v155
    v_sub_u32 v154, v154, v156
    v_lshrrev_b32 v156, 1, v155
    v_and_b32 v156, 4, v156
    v_xor_b32 v155, v155, v156
    v_lshrrev_b32 v156, 3, v155
    v_lshl_add_u32 v155, v156, 5, v155
    v_add_u32 v155, 16, v155
    v_mul_u32_u24 v155, 1280, v155
    v_lshl_add_u32 v154, v154, 4, v155
    v_add_u32 v84, s95, v154
    s_add_u32 s7, s11, 0
    s_add_u32 m0, s6, 55296
    s_nop 0
    buffer_load_dwordx4 v80, s[48:51], s7 offen lds
    s_add_u32 m0, s6, 56320
    s_nop 0
    buffer_load_dwordx4 v81, s[48:51], s7 offen lds
    s_add_u32 m0, s6, 57344
    s_nop 0
    buffer_load_dwordx4 v82, s[48:51], s7 offen lds
    s_add_u32 m0, s6, 58368
    s_nop 0
    buffer_load_dwordx4 v83, s[48:51], s7 offen lds
    s_add_u32 m0, s6, 59392
    s_nop 0
    buffer_load_dwordx4 v84, s[48:51], s7 offen lds
    s_barrier
    s_mul_i32 s11, s61, 51200
    s_mul_i32 s6, s61, 5120
    s_add_u32 s7, s11, 409600
    s_add_u32 m0, s6, 118784
    s_nop 0
    buffer_load_dwordx4 v144, s[48:51], s7 offen lds
    s_add_u32 m0, s6, 119808
    s_nop 0
    buffer_load_dwordx4 v145, s[48:51], s7 offen lds
    s_add_u32 m0, s6, 120832
    s_nop 0
    buffer_load_dwordx4 v146, s[48:51], s7 offen lds
    s_add_u32 m0, s6, 121856
    s_nop 0
    buffer_load_dwordx4 v147, s[48:51], s7 offen lds
    s_add_u32 m0, s6, 122880
    s_nop 0
    buffer_load_dwordx4 v148, s[48:51], s7 offen lds
    s_mul_i32 s11, s61, 51200
    s_mul_i32 s6, s61, 5120
    s_add_u32 s7, s11, 614400
    s_add_u32 m0, s6, 139264
    s_nop 0
    buffer_load_dwordx4 v144, s[48:51], s7 offen lds
    s_add_u32 m0, s6, 140288
    s_nop 0
    buffer_load_dwordx4 v145, s[48:51], s7 offen lds
    s_add_u32 m0, s6, 141312
    s_nop 0
    buffer_load_dwordx4 v146, s[48:51], s7 offen lds
    s_add_u32 m0, s6, 142336
    s_nop 0
    buffer_load_dwordx4 v147, s[48:51], s7 offen lds
    s_add_u32 m0, s6, 143360
    s_nop 0
    buffer_load_dwordx4 v148, s[48:51], s7 offen lds
    v_mov_b32 v161, 159744
    s_barrier
    s_barrier
    ds_read_b32 v161, v161
    s_waitcnt lgkmcnt(0)
    v_readfirstlane_b32 s12, v161
    v_sub_f32 v157, 1.0, v160
    v_lshrrev_b32 v154, 4, v167
    v_lshlrev_b32 v154, 9, v154
    v_and_b32 v155, 0x1ff, v165
    v_lshrrev_b32 v155, 1, v155
    v_add_u32 v154, v154, v155
    v_mov_b32 v161, v163
    v_mov_b32 v162, v164
    s_cmp_eq_u32 s12, 0
    s_cbranch_scc1 L_p4
    v_mov_b32 v41, v154
    s_mov_b32 s15, 0
    s_mov_b32 s19, 8
    s_waitcnt vmcnt(0)
L_lmax:
    s_barrier
    s_add_u32 m0, s17, 32768
    s_sub_u32 s21, s90, s17
    buffer_load_dwordx4 v166, s[28:31], s15 offen offset:0 sc1 lds
    buffer_load_dwordx4 v166, s[28:31], s15 offen offset:1024 sc1 lds
    s_add_u32 m0, s91, 32768
    s_add_u32 s21, s21, s15
    buffer_load_dwordx4 v150, s[28:31], s15 offen offset:0 sc1 lds
    buffer_load_dwordx4 v151, s[28:31], s15 offen offset:1024 sc1 lds
    buffer_load_dwordx4 v152, s[28:31], s15 offen offset:2048 sc1 lds
    s_add_u32 m0, s90, 32768
    s_mov_b32 exec_hi, 0
    buffer_load_dwordx4 v166, s[28:31], s21 offen sc1 lds
    s_mov_b64 exec, -1
    s_waitcnt vmcnt(0)
    s_barrier
    s_add_u32 s15, s15, 22528
    s_sub_u32 s19, s19, 1
    s_cmp_lg_u32 s19, 0
    s_cbranch_scc1 L_lmax
    s_barrier
    s_mov_b32 s15, 0
    s_add_u32 m0, s17, 0
    s_sub_u32 s21, s90, s17
    buffer_load_dwordx4 v166, s[28:31], s15 offen offset:0 sc1 lds
    buffer_load_dwordx4 v166, s[28:31], s15 offen offset:1024 sc1 lds
    s_add_u32 m0, s91, 0
    s_add_u32 s21, s21, s15
    buffer_load_dwordx4 v150, s[28:31], s15 offen offset:0 sc1 lds
    buffer_load_dwordx4 v151, s[28:31], s15 offen offset:1024 sc1 lds
    buffer_load_dwordx4 v152, s[28:31], s15 offen offset:2048 sc1 lds
    s_add_u32 m0, s90, 0
    s_mov_b32 exec_hi, 0
    buffer_load_dwordx4 v166, s[28:31], s21 offen sc1 lds
    s_mov_b64 exec, -1
    s_mov_b32 s15, 22528
    s_add_u32 m0, s17, 32768
    s_sub_u32 s21, s90, s17
    buffer_load_dwordx4 v166, s[28:31], s15 offen offset:0 sc1 lds
    buffer_load_dwordx4 v166, s[28:31], s15 offen offset:1024 sc1 lds
    s_add_u32 m0, s91, 32768
    s_add_u32 s21, s21, s15
    buffer_load_dwordx4 v150, s[28:31], s15 offen offset:0 sc1 lds
    buffer_load_dwordx4 v151, s[28:31], s15 offen offset:1024 sc1 lds
    buffer_load_dwordx4 v152, s[28:31], s15 offen offset:2048 sc1 lds
    s_add_u32 m0, s90, 32768
    s_mov_b32 exec_hi, 0
    buffer_load_dwordx4 v166, s[28:31], s21 offen sc1 lds
    s_mov_b64 exec, -1
    s_mov_b32 s15, 45056
    s_add_u32 m0, s17, 55296
    s_sub_u32 s21, s90, s17
    buffer_load_dwordx4 v166, s[28:31], s15 offen offset:0 sc1 lds
    buffer_load_dwordx4 v166, s[28:31], s15 offen offset:1024 sc1 lds
    s_add_u32 m0, s91, 55296
    s_add_u32 s21, s21, s15
    buffer_load_dwordx4 v150, s[28:31], s15 offen offset:0 sc1 lds
    buffer_load_dwordx4 v151, s[28:31], s15 offen offset:1024 sc1 lds
    buffer_load_dwordx4 v152, s[28:31], s15 offen offset:2048 sc1 lds
    s_add_u32 m0, s90, 55296
    s_mov_b32 exec_hi, 0
    buffer_load_dwordx4 v166, s[28:31], s21 offen sc1 lds
    s_mov_b64 exec, -1
    s_waitcnt vmcnt(0)
    s_barrier
    s_barrier
    s_barrier
    s_mov_b32 s15, 67584
    s_add_u32 m0, s17, 0
    s_sub_u32 s21, s90, s17
    buffer_load_dwordx4 v166, s[28:31], s15 offen offset:0 sc1 lds
    buffer_load_dwordx4 v166, s[28:31], s15 offen offset:1024 sc1 lds
    s_add_u32 m0, s91, 0
    s_add_u32 s21, s21, s15
    buffer_load_dwordx4 v150, s[28:31], s15 offen offset:0 sc1 lds
    buffer_load_dwordx4 v151, s[28:31], s15 offen offset:1024 sc1 lds
    buffer_load_dwordx4 v152, s[28:31], s15 offen offset:2048 sc1 lds
    s_add_u32 m0, s90, 0
    s_mov_b32 exec_hi, 0
    buffer_load_dwordx4 v166, s[28:31], s21 offen sc1 lds
    s_mov_b64 exec, -1
    s_waitcnt vmcnt(0)
    s_barrier
    s_mov_b32 s15, 90112
    s_add_u32 m0, s17, 32768
    s_sub_u32 s21, s90, s17
    buffer_load_dwordx4 v166, s[28:31], s15 offen offset:0 sc1 lds
    buffer_load_dwordx4 v166, s[28:31], s15 offen offset:1024 sc1 lds
    s_add_u32 m0, s91, 32768
    s_add_u32 s21, s21, s15
    buffer_load_dwordx4 v150, s[28:31], s15 offen offset:0 sc1 lds
    buffer_load_dwordx4 v151, s[28:31], s15 offen offset:1024 sc1 lds
    buffer_load_dwordx4 v152, s[28:31], s15 offen offset:2048 sc1 lds
    s_add_u32 m0, s90, 32768
    s_mov_b32 exec_hi, 0
    buffer_load_dwordx4 v166, s[28:31], s21 offen sc1 lds
    s_mov_b64 exec, -1
    s_waitcnt vmcnt(0)
    s_barrier
    s_mov_b32 s15, 112640
    s_add_u32 m0, s17, 55296
    s_sub_u32 s21, s90, s17
    buffer_load_dwordx4 v166, s[28:31], s15 offen offset:0 sc1 lds
    buffer_load_dwordx4 v166, s[28:31], s15 offen offset:1024 sc1 lds
    s_add_u32 m0, s91, 55296
    s_add_u32 s21, s21, s15
    buffer_load_dwordx4 v150, s[28:31], s15 offen offset:0 sc1 lds
    buffer_load_dwordx4 v151, s[28:31], s15 offen offset:1024 sc1 lds
    buffer_load_dwordx4 v152, s[28:31], s15 offen offset:2048 sc1 lds
    s_add_u32 m0, s90, 55296
    s_mov_b32 exec_hi, 0
    buffer_load_dwordx4 v166, s[28:31], s21 offen sc1 lds
    s_mov_b64 exec, -1
    s_waitcnt vmcnt(0)
    s_barrier
    s_mov_b32 s15, 135168
    s_add_u32 m0, s17, 0
    s_sub_u32 s21, s90, s17
    buffer_load_dwordx4 v166, s[28:31], s15 offen offset:0 sc1 lds
    buffer_load_dwordx4 v166, s[28:31], s15 offen offset:1024 sc1 lds
    s_add_u32 m0, s91, 0
    s_add_u32 s21, s21, s15
    buffer_load_dwordx4 v150, s[28:31], s15 offen offset:0 sc1 lds
    buffer_load_dwordx4 v151, s[28:31], s15 offen offset:1024 sc1 lds
    buffer_load_dwordx4 v152, s[28:31], s15 offen offset:2048 sc1 lds
    s_add_u32 m0, s90, 0
    s_mov_b32 exec_hi, 0
    buffer_load_dwordx4 v166, s[28:31], s21 offen sc1 lds
    s_mov_b64 exec, -1
    s_waitcnt vmcnt(0)
    s_barrier
    s_mov_b32 s15, 157696
    s_add_u32 m0, s17, 32768
    s_sub_u32 s21, s90, s17
    buffer_load_dwordx4 v166, s[28:31], s15 offen offset:0 sc1 lds
    buffer_load_dwordx4 v166, s[28:31], s15 offen offset:1024 sc1 lds
    s_add_u32 m0, s91, 32768
    s_add_u32 s21, s21, s15
    buffer_load_dwordx4 v150, s[28:31], s15 offen offset:0 sc1 lds
    buffer_load_dwordx4 v151, s[28:31], s15 offen offset:1024 sc1 lds
    buffer_load_dwordx4 v152, s[28:31], s15 offen offset:2048 sc1 lds
    s_add_u32 m0, s90, 32768
    s_mov_b32 exec_hi, 0
    buffer_load_dwordx4 v166, s[28:31], s21 offen sc1 lds
    s_mov_b64 exec, -1
    s_waitcnt vmcnt(0)
    s_barrier
    s_mul_i32 s11, s61, 204800
    s_mul_i32 s6, s61, 5120
    s_mov_b32 s3, 0x1999999a
    s_mul_i32 s95, s63, 160
    v_add_u32 v154, 0, v167
    v_mul_hi_u32 v155, v154, s3
    v_mul_u32_u24 v156, 10, v155
    v_sub_u32 v154, v154, v156
    v_lshrrev_b32 v156, 1, v155
    v_and_b32 v156, 4, v156
    v_xor_b32 v155, v155, v156
    v_lshrrev_b32 v156, 3, v155
    v_lshl_add_u32 v155, v156, 5, v155
    v_add_u32 v155, 16, v155
    v_mul_u32_u24 v155, 1280, v155
    v_lshl_add_u32 v154, v154, 4, v155
    v_add_u32 v80, s95, v154
    v_add_u32 v154, 64, v167
    v_mul_hi_u32 v155, v154, s3
    v_mul_u32_u24 v156, 10, v155
    v_sub_u32 v154, v154, v156
    v_lshrrev_b32 v156, 1, v155
    v_and_b32 v156, 4, v156
    v_xor_b32 v155, v155, v156
    v_lshrrev_b32 v156, 3, v155
    v_lshl_add_u32 v155, v156, 5, v155
    v_add_u32 v155, 16, v155
    v_mul_u32_u24 v155, 1280, v155
    v_lshl_add_u32 v154, v154, 4, v155
    v_add_u32 v81, s95, v154
    v_add_u32 v154, 128, v167
    v_mul_hi_u32 v155, v154, s3
    v_mul_u32_u24 v156, 10, v155
    v_sub_u32 v154, v154, v156
    v_lshrrev_b32 v156, 1, v155
    v_and_b32 v156, 4, v156
    v_xor_b32 v155, v155, v156
    v_lshrrev_b32 v156, 3, v155
    v_lshl_add_u32 v155, v156, 5, v155
    v_add_u32 v155, 16, v155
    v_mul_u32_u24 v155, 1280, v155
    v_lshl_add_u32 v154, v154, 4, v155
    v_add_u32 v82, s95, v154
    v_add_u32 v154, 192, v167
    v_mul_hi_u32 v155, v154, s3
    v_mul_u32_u24 v156, 10, v155
    v_sub_u32 v154, v154, v156
    v_lshrrev_b32 v156, 1, v155
    v_and_b32 v156, 4, v156
    v_xor_b32 v155, v155, v156
    v_lshrrev_b32 v156, 3, v155
    v_lshl_add_u32 v155, v156, 5, v155
    v_add_u32 v155, 16, v155
    v_mul_u32_u24 v155, 1280, v155
    v_lshl_add_u32 v154, v154, 4, v155
    v_add_u32 v83, s95, v154
    v_add_u32 v154, 256, v167
    v_mul_hi_u32 v155, v154, s3
    v_mul_u32_u24 v156, 10, v155
    v_sub_u32 v154, v154, v156
    v_lshrrev_b32 v156, 1, v155
    v_and_b32 v156, 4, v156
    v_xor_b32 v155, v155, v156
    v_lshrrev_b32 v156, 3, v155
    v_lshl_add_u32 v155, v156, 5, v155
    v_add_u32 v155, 16, v155
    v_mul_u32_u24 v155, 1280, v155
    v_lshl_add_u32 v154, v154, 4, v155
    v_add_u32 v84, s95, v154
    s_add_u32 s7, s11, 0
    s_add_u32 m0, s6, 55296
    s_nop 0
    buffer_load_dwordx4 v80, s[48:51], s7 offen lds
    s_add_u32 m0, s6, 56320
    s_nop 0
    buffer_load_dwordx4 v81, s[48:51], s7 offen lds
    s_add_u32 m0, s6, 57344
    s_nop 0
    buffer_load_dwordx4 v82, s[48:51], s7 offen lds
    s_add_u32 m0, s6, 58368
    s_nop 0
    buffer_load_dwordx4 v83, s[48:51], s7 offen lds
    s_add_u32 m0, s6, 59392
    s_nop 0
    buffer_load_dwordx4 v84, s[48:51], s7 offen lds
    v_mov_b32 v154, v41
    s_barrier
    s_barrier
    s_waitcnt vmcnt(0)
    s_barrier
L_p4:
    s_mul_i32 s24, s61, 5120
    s_xor_b32 s25, s61, 1
    s_mul_i32 s25, s25, 5120
    v_lshlrev_b32 v60, 4, v167
    v_add_u32 v166, s25, v60
    v_add_u32 v60, s24, v60
    v_sub_f32 v61, 1.0, v160
    ds_write_b128 v60, v[20:23] offset:0
    ds_write_b128 v60, v[24:27] offset:1024
    ds_write_b128 v60, v[28:31] offset:2048
    ds_write_b128 v60, v[32:35] offset:3072
    ds_write_b128 v60, v[36:39] offset:4096
    s_waitcnt vmcnt(0)
    s_waitcnt lgkmcnt(0)
    s_barrier
    ds_read_b128 v[40:43], v166 offset:0
    ds_read_b128 v[44:47], v166 offset:1024
    ds_read_b128 v[48:51], v166 offset:2048
    ds_read_b128 v[52:55], v166 offset:3072
    ds_read_b128 v[56:59], v166 offset:4096
    v_and_b32 v62, 15, v167
    s_lshl_b32 s3, s14, 12
    s_add_u32 s3, s3, 32768
    v_lshl_add_u32 v62, v62, 8, s3
    s_lshl_b32 s3, s14, 14
    s_add_u32 s26, s5, s3
    s_lshl_b32 s3, s14, 12
    s_add_u32 s27, s5, s3
    s_add_u32 s27, s27, 32768
    s_mul_i32 s28, s14, 40960
    s_mul_i32 s29, s14, 10240
    s_add_u32 s29, s29, 4294944768
    s_waitcnt lgkmcnt(0)
    v_add_f32 v0, v0, v40
    v_add_f32 v1, v1, v41
    v_add_f32 v2, v2, v42
    v_add_f32 v3, v3, v43
    v_add_f32 v4, v4, v44
    v_add_f32 v5, v5, v45
    v_add_f32 v6, v6, v46
    v_add_f32 v7, v7, v47
    v_add_f32 v8, v8, v48
    v_add_f32 v9, v9, v49
    v_add_f32 v10, v10, v50
    v_add_f32 v11, v11, v51
    v_add_f32 v12, v12, v52
    v_add_f32 v13, v13, v53
    v_add_f32 v14, v14, v54
    v_add_f32 v15, v15, v55
    v_add_f32 v16, v16, v56
    v_add_f32 v17, v17, v57
    v_add_f32 v18, v18, v58
    v_add_f32 v19, v19, v59
    v_mul_f32 v40, v0, v61
    v_mul_f32 v41, v1, v61
    v_mul_f32 v42, v2, v61
    v_mul_f32 v43, v3, v61
    v_mul_f32 v44, v4, v61
    v_mul_f32 v45, v5, v61
    v_mul_f32 v46, v6, v61
    v_mul_f32 v47, v7, v61
    v_mul_f32 v48, v8, v61
    v_mul_f32 v49, v9, v61
    v_mul_f32 v50, v10, v61
    v_mul_f32 v51, v11, v61
    v_mul_f32 v52, v12, v61
    v_mul_f32 v53, v13, v61
    v_mul_f32 v54, v14, v61
    v_mul_f32 v55, v15, v61
    v_mul_f32 v56, v16, v61
    v_mul_f32 v57, v17, v61
    v_mul_f32 v58, v18, v61
    v_mul_f32 v59, v19, v61
    ds_write_b128 v166, v[40:43] offset:0
    ds_write_b128 v166, v[44:47] offset:1024
    ds_write_b128 v166, v[48:51] offset:2048
    ds_write_b128 v166, v[52:55] offset:3072
    ds_write_b128 v166, v[56:59] offset:4096
    v_mov_b32 v0, 0
    v_mov_b32 v1, 0
    v_mov_b32 v2, 0
    v_mov_b32 v3, 0
    v_mov_b32 v4, 0
    v_mov_b32 v5, 0
    v_mov_b32 v6, 0
    v_mov_b32 v7, 0
    v_mov_b32 v8, 0
    v_mov_b32 v9, 0
    v_mov_b32 v10, 0
    v_mov_b32 v11, 0
    v_mov_b32 v12, 0
    v_mov_b32 v13, 0
    v_mov_b32 v14, 0
    v_mov_b32 v15, 0
    v_mov_b32 v16, 0
    v_mov_b32 v17, 0
    v_mov_b32 v18, 0
    v_mov_b32 v19, 0
    v_mov_b32 v20, 0
    v_mov_b32 v21, 0
    v_mov_b32 v22, 0
    v_mov_b32 v23, 0
    v_mov_b32 v24, 0
    v_mov_b32 v25, 0
    v_mov_b32 v26, 0
    v_mov_b32 v27, 0
    v_mov_b32 v28, 0
    v_mov_b32 v29, 0
    v_mov_b32 v30, 0
    v_mov_b32 v31, 0
    v_mov_b32 v32, 0
    v_mov_b32 v33, 0
    v_mov_b32 v34, 0
    v_mov_b32 v35, 0
    v_mov_b32 v36, 0
    v_mov_b32 v37, 0
    v_mov_b32 v38, 0
    v_mov_b32 v39, 0
    v_add_u32 v161, s28, v163
    v_add_u32 v162, s28, v164
    v_mov_b32 v63, v154
    v_xor_b32 v64, 0x80, v154
    v_mov_b32 v65, v153
    s_waitcnt lgkmcnt(0)
    s_mov_b32 s3, 524288
L_poll3:
    buffer_load_dword v159, v62, s[56:59], s5 offen sc1
    s_sub_u32 s3, s3, 1
    s_cmp_eq_u32 s3, 0
    s_cbranch_scc1 L_poll3_ok
    s_waitcnt vmcnt(0)
    v_cmp_eq_u32 vcc, -1, v159
    s_nop 4
    s_cbranch_vccz L_poll3_ok
    s_sleep 4
    s_branch L_poll3
L_poll3_ok:
    s_add_u32 s4, s26, 0
    buffer_load_dwordx4 v[80:83], v165, s[56:59], s4 offen offset:0 sc1
    buffer_load_dwordx4 v[84:87], v65, s[56:59], s4 offen offset:0 sc1
    buffer_load_dwordx4 v[88:91], v165, s[56:59], s4 offen offset:2048 sc1
    buffer_load_dwordx4 v[92:95], v65, s[56:59], s4 offen offset:2048 sc1
    s_add_u32 s4, s26, 4096
    buffer_load_dwordx4 v[96:99], v165, s[56:59], s4 offen offset:0 sc1
    buffer_load_dwordx4 v[100:103], v65, s[56:59], s4 offen offset:0 sc1
    buffer_load_dwordx4 v[104:107], v165, s[56:59], s4 offen offset:2048 sc1
    buffer_load_dwordx4 v[108:111], v65, s[56:59], s4 offen offset:2048 sc1
    s_add_u32 s4, s26, 8192
    buffer_load_dwordx4 v[112:115], v165, s[56:59], s4 offen offset:0 sc1
    buffer_load_dwordx4 v[116:119], v65, s[56:59], s4 offen offset:0 sc1
    buffer_load_dwordx4 v[120:123], v165, s[56:59], s4 offen offset:2048 sc1
    buffer_load_dwordx4 v[124:127], v65, s[56:59], s4 offen offset:2048 sc1
    s_add_u32 s4, s26, 12288
    buffer_load_dwordx4 v[128:131], v165, s[56:59], s4 offen offset:0 sc1
    buffer_load_dwordx4 v[132:135], v65, s[56:59], s4 offen offset:0 sc1
    buffer_load_dwordx4 v[136:139], v165, s[56:59], s4 offen offset:2048 sc1
    buffer_load_dwordx4 v[140:143], v65, s[56:59], s4 offen offset:2048 sc1
    buffer_load_dwordx2 v[144:145], v63, s[56:59], s27 offen offset:0 sc1
    buffer_load_dwordx2 v[146:147], v63, s[56:59], s27 offen offset:256 sc1
    buffer_load_dwordx2 v[148:149], v64, s[56:59], s27 offen offset:0 sc1
    buffer_load_dwordx2 v[150:151], v64, s[56:59], s27 offen offset:256 sc1
    buffer_load_dwordx2 v[152:153], v63, s[56:59], s27 offen offset:2048 sc1
    buffer_load_dwordx2 v[154:155], v63, s[56:59], s27 offen offset:2304 sc1
    buffer_load_dwordx2 v[156:157], v64, s[56:59], s27 offen offset:2048 sc1
    buffer_load_dwordx2 v[158:159], v64, s[56:59], s27 offen offset:2304 sc1
    s_mov_b32 s10, 524288
    ds_read_b64_tr_b16 v[40:41], v161 offset:0
    ds_read_b64_tr_b16 v[42:43], v162 offset:0
    ds_read_b64_tr_b16 v[44:45], v161 offset:8
    ds_read_b64_tr_b16 v[46:47], v162 offset:8
    ds_read_b64_tr_b16 v[48:49], v161 offset:16
    ds_read_b64_tr_b16 v[50:51], v162 offset:16
    ds_read_b64_tr_b16 v[52:53], v161 offset:24
    ds_read_b64_tr_b16 v[54:55], v162 offset:24
    ds_read_b64_tr_b16 v[56:57], v161 offset:32
    ds_read_b64_tr_b16 v[58:59], v162 offset:32
    s_waitcnt vmcnt(22)
L_chk0:
    v_max3_u32 v60, v80, v81, v82
    v_max3_u32 v60, v60, v83, v84
    v_max3_u32 v60, v60, v85, v86
    v_max_u32 v60, v60, v87
    v_cmp_eq_u32 vcc, -1, v60
    s_nop 4
    s_cbranch_vccnz L_retry0
L_ok0:
    s_waitcnt lgkmcnt(6)
    v_mfma_f32_16x16x32_bf16 v[0:3], v[40:43], v[80:83], v[0:3]
    ds_read_b64_tr_b16 v[60:61], v161 offset:5120
    v_mfma_f32_16x16x32_bf16 v[20:23], v[40:43], v[84:87], v[20:23]
    ds_read_b64_tr_b16 v[62:63], v162 offset:5120
    v_mfma_f32_16x16x32_bf16 v[4:7], v[44:47], v[80:83], v[4:7]
    ds_read_b64_tr_b16 v[64:65], v161 offset:5128
    v_mfma_f32_16x16x32_bf16 v[24:27], v[44:47], v[84:87], v[24:27]
    ds_read_b64_tr_b16 v[66:67], v162 offset:5128
    s_waitcnt lgkmcnt(6)
    v_mfma_f32_16x16x32_bf16 v[8:11], v[48:51], v[80:83], v[8:11]
    ds_read_b64_tr_b16 v[68:69], v161 offset:5136
    v_mfma_f32_16x16x32_bf16 v[28:31], v[48:51], v[84:87], v[28:31]
    ds_read_b64_tr_b16 v[70:71], v162 offset:5136
    v_mfma_f32_16x16x32_bf16 v[12:15], v[52:55], v[80:83], v[12:15]
    ds_read_b64_tr_b16 v[72:73], v161 offset:5144
    v_mfma_f32_16x16x32_bf16 v[32:35], v[52:55], v[84:87], v[32:35]
    ds_read_b64_tr_b16 v[74:75], v162 offset:5144
    s_waitcnt lgkmcnt(8)
    v_mfma_f32_16x16x32_bf16 v[16:19], v[56:59], v[80:83], v[16:19]
    ds_read_b64_tr_b16 v[76:77], v161 offset:5152
    v_mfma_f32_16x16x32_bf16 v[36:39], v[56:59], v[84:87], v[36:39]
    ds_read_b64_tr_b16 v[78:79], v162 offset:5152
    s_waitcnt vmcnt(18)
L_chk1:
    v_max3_u32 v40, v88, v89, v90
    v_max3_u32 v40, v40, v91, v92
    v_max3_u32 v40, v40, v93, v94
    v_max3_u32 v40, v40, v95, v96
    v_max3_u32 v40, v40, v97, v98
    v_max3_u32 v40, v40, v99, v100
    v_max3_u32 v40, v40, v101, v102
    v_max_u32 v40, v40, v103
    v_cmp_eq_u32 vcc, -1, v40
    s_nop 4
    s_cbranch_vccnz L_retry1
L_ok1:
    s_waitcnt lgkmcnt(6)
    v_mfma_f32_16x16x32_bf16 v[0:3], v[60:63], v[88:91], v[0:3]
    ds_read_b64_tr_b16 v[40:41], v161 offset:10240
    v_mfma_f32_16x16x32_bf16 v[20:23], v[60:63], v[92:95], v[20:23]
    ds_read_b64_tr_b16 v[42:43], v162 offset:10240
    v_mfma_f32_16x16x32_bf16 v[4:7], v[64:67], v[88:91], v[4:7]
    ds_read_b64_tr_b16 v[44:45], v161 offset:10248
    v_mfma_f32_16x16x32_bf16 v[24:27], v[64:67], v[92:95], v[24:27]
    ds_read_b64_tr_b16 v[46:47], v162 offset:10248
    s_waitcnt lgkmcnt(6)
    v_mfma_f32_16x16x32_bf16 v[8:11], v[68:71], v[88:91], v[8:11]
    ds_read_b64_tr_b16 v[48:49], v161 offset:10256
    v_mfma_f32_16x16x32_bf16 v[28:31], v[68:71], v[92:95], v[28:31]
    ds_read_b64_tr_b16 v[50:51], v162 offset:10256
    v_mfma_f32_16x16x32_bf16 v[12:15], v[72:75], v[88:91], v[12:15]
    ds_read_b64_tr_b16 v[52:53], v161 offset:10264
    v_mfma_f32_16x16x32_bf16 v[32:35], v[72:75], v[92:95], v[32:35]
    ds_read_b64_tr_b16 v[54:55], v162 offset:10264
    s_waitcnt lgkmcnt(8)
    v_mfma_f32_16x16x32_bf16 v[16:19], v[76:79], v[88:91], v[16:19]
    ds_read_b64_tr_b16 v[56:57], v161 offset:10272
    v_mfma_f32_16x16x32_bf16 v[36:39], v[76:79], v[92:95], v[36:39]
    ds_read_b64_tr_b16 v[58:59], v162 offset:10272
    s_waitcnt lgkmcnt(6)
    v_mfma_f32_16x16x32_bf16 v[0:3], v[40:43], v[96:99], v[0:3]
    ds_read_b64_tr_b16 v[60:61], v161 offset:15360
    v_mfma_f32_16x16x32_bf16 v[20:23], v[40:43], v[100:103], v[20:23]
    ds_read_b64_tr_b16 v[62:63], v162 offset:15360
    v_mfma_f32_16x16x32_bf16 v[4:7], v[44:47], v[96:99], v[4:7]
    ds_read_b64_tr_b16 v[64:65], v161 offset:15368
    v_mfma_f32_16x16x32_bf16 v[24:27], v[44:47], v[100:103], v[24:27]
    ds_read_b64_tr_b16 v[66:67], v162 offset:15368
    s_waitcnt lgkmcnt(6)
    v_mfma_f32_16x16x32_bf16 v[8:11], v[48:51], v[96:99], v[8:11]
    ds_read_b64_tr_b16 v[68:69], v161 offset:15376
    v_mfma_f32_16x16x32_bf16 v[28:31], v[48:51], v[100:103], v[28:31]
    ds_read_b64_tr_b16 v[70:71], v162 offset:15376
    v_mfma_f32_16x16x32_bf16 v[12:15], v[52:55], v[96:99], v[12:15]
    ds_read_b64_tr_b16 v[72:73], v161 offset:15384
    v_mfma_f32_16x16x32_bf16 v[32:35], v[52:55], v[100:103], v[32:35]
    ds_read_b64_tr_b16 v[74:75], v162 offset:15384
    s_waitcnt lgkmcnt(8)
    v_mfma_f32_16x16x32_bf16 v[16:19], v[56:59], v[96:99], v[16:19]
    ds_read_b64_tr_b16 v[76:77], v161 offset:15392
    v_mfma_f32_16x16x32_bf16 v[36:39], v[56:59], v[100:103], v[36:39]
    ds_read_b64_tr_b16 v[78:79], v162 offset:15392
    s_waitcnt vmcnt(14)
L_chk3:
    v_max3_u32 v40, v104, v105, v106
    v_max3_u32 v40, v40, v107, v108
    v_max3_u32 v40, v40, v109, v110
    v_max3_u32 v40, v40, v111, v112
    v_max3_u32 v40, v40, v113, v114
    v_max3_u32 v40, v40, v115, v116
    v_max3_u32 v40, v40, v117, v118
    v_max_u32 v40, v40, v119
    v_cmp_eq_u32 vcc, -1, v40
    s_nop 4
    s_cbranch_vccnz L_retry3
L_ok3:
    s_waitcnt lgkmcnt(6)
    v_mfma_f32_16x16x32_bf16 v[0:3], v[60:63], v[104:107], v[0:3]
    ds_read_b64_tr_b16 v[40:41], v161 offset:20480
    v_mfma_f32_16x16x32_bf16 v[20:23], v[60:63], v[108:111], v[20:23]
    ds_read_b64_tr_b16 v[42:43], v162 offset:20480
    v_mfma_f32_16x16x32_bf16 v[4:7], v[64:67], v[104:107], v[4:7]
    ds_read_b64_tr_b16 v[44:45], v161 offset:20488
    v_mfma_f32_16x16x32_bf16 v[24:27], v[64:67], v[108:111], v[24:27]
    ds_read_b64_tr_b16 v[46:47], v162 offset:20488
    s_waitcnt lgkmcnt(6)
    v_mfma_f32_16x16x32_bf16 v[8:11], v[68:71], v[104:107], v[8:11]
    ds_read_b64_tr_b16 v[48:49], v161 offset:20496
    v_mfma_f32_16x16x32_bf16 v[28:31], v[68:71], v[108:111], v[28:31]
    ds_read_b64_tr_b16 v[50:51], v162 offset:20496
    v_mfma_f32_16x16x32_bf16 v[12:15], v[72:75], v[104:107], v[12:15]
    ds_read_b64_tr_b16 v[52:53], v161 offset:20504
    v_mfma_f32_16x16x32_bf16 v[32:35], v[72:75], v[108:111], v[32:35]
    ds_read_b64_tr_b16 v[54:55], v162 offset:20504
    s_waitcnt lgkmcnt(8)
    v_mfma_f32_16x16x32_bf16 v[16:19], v[76:79], v[104:107], v[16:19]
    ds_read_b64_tr_b16 v[56:57], v161 offset:20512
    v_mfma_f32_16x16x32_bf16 v[36:39], v[76:79], v[108:111], v[36:39]
    ds_read_b64_tr_b16 v[58:59], v162 offset:20512
    s_waitcnt lgkmcnt(6)
    v_mfma_f32_16x16x32_bf16 v[0:3], v[40:43], v[112:115], v[0:3]
    ds_read_b64_tr_b16 v[60:61], v161 offset:25600
    v_mfma_f32_16x16x32_bf16 v[20:23], v[40:43], v[116:119], v[20:23]
    ds_read_b64_tr_b16 v[62:63], v162 offset:25600
    v_mfma_f32_16x16x32_bf16 v[4:7], v[44:47], v[112:115], v[4:7]
    ds_read_b64_tr_b16 v[64:65], v161 offset:25608
    v_mfma_f32_16x16x32_bf16 v[24:27], v[44:47], v[116:119], v[24:27]
    ds_read_b64_tr_b16 v[66:67], v162 offset:25608
    s_waitcnt lgkmcnt(6)
    v_mfma_f32_16x16x32_bf16 v[8:11], v[48:51], v[112:115], v[8:11]
    ds_read_b64_tr_b16 v[68:69], v161 offset:25616
    v_mfma_f32_16x16x32_bf16 v[28:31], v[48:51], v[116:119], v[28:31]
    ds_read_b64_tr_b16 v[70:71], v162 offset:25616
    v_mfma_f32_16x16x32_bf16 v[12:15], v[52:55], v[112:115], v[12:15]
    ds_read_b64_tr_b16 v[72:73], v161 offset:25624
    v_mfma_f32_16x16x32_bf16 v[32:35], v[52:55], v[116:119], v[32:35]
    ds_read_b64_tr_b16 v[74:75], v162 offset:25624
    s_waitcnt lgkmcnt(8)
    v_mfma_f32_16x16x32_bf16 v[16:19], v[56:59], v[112:115], v[16:19]
    ds_read_b64_tr_b16 v[76:77], v161 offset:25632
    v_mfma_f32_16x16x32_bf16 v[36:39], v[56:59], v[116:119], v[36:39]
    ds_read_b64_tr_b16 v[78:79], v162 offset:25632
    s_waitcnt vmcnt(10)
L_chk5:
    v_max3_u32 v40, v120, v121, v122
    v_max3_u32 v40, v40, v123, v124
    v_max3_u32 v40, v40, v125, v126
    v_max3_u32 v40, v40, v127, v128
    v_max3_u32 v40, v40, v129, v130
    v_max3_u32 v40, v40, v131, v132
    v_max3_u32 v40, v40, v133, v134
    v_max_u32 v40, v40, v135
    v_cmp_eq_u32 vcc, -1, v40
    s_nop 4
    s_cbranch_vccnz L_retry5
L_ok5:
    s_waitcnt lgkmcnt(6)
    v_mfma_f32_16x16x32_bf16 v[0:3], v[60:63], v[120:123], v[0:3]
    ds_read_b64_tr_b16 v[40:41], v161 offset:30720
    v_mfma_f32_16x16x32_bf16 v[20:23], v[60:63], v[124:127], v[20:23]
    ds_read_b64_tr_b16 v[42:43], v162 offset:30720
    v_mfma_f32_16x16x32_bf16 v[4:7], v[64:67], v[120:123], v[4:7]
    ds_read_b64_tr_b16 v[44:45], v161 offset:30728
    v_mfma_f32_16x16x32_bf16 v[24:27], v[64:67], v[124:127], v[24:27]
    ds_read_b64_tr_b16 v[46:47], v162 offset:30728
    s_waitcnt lgkmcnt(6)
    v_mfma_f32_16x16x32_bf16 v[8:11], v[68:71], v[120:123], v[8:11]
    ds_read_b64_tr_b16 v[48:49], v161 offset:30736
    v_mfma_f32_16x16x32_bf16 v[28:31], v[68:71], v[124:127], v[28:31]
    ds_read_b64_tr_b16 v[50:51], v162 offset:30736
    v_mfma_f32_16x16x32_bf16 v[12:15], v[72:75], v[120:123], v[12:15]
    ds_read_b64_tr_b16 v[52:53], v161 offset:30744
    v_mfma_f32_16x16x32_bf16 v[32:35], v[72:75], v[124:127], v[32:35]
    ds_read_b64_tr_b16 v[54:55], v162 offset:30744
    s_waitcnt lgkmcnt(8)
    v_mfma_f32_16x16x32_bf16 v[16:19], v[76:79], v[120:123], v[16:19]
    ds_read_b64_tr_b16 v[56:57], v161 offset:30752
    v_mfma_f32_16x16x32_bf16 v[36:39], v[76:79], v[124:127], v[36:39]
    ds_read_b64_tr_b16 v[58:59], v162 offset:30752
    s_waitcnt lgkmcnt(6)
    v_mfma_f32_16x16x32_bf16 v[0:3], v[40:43], v[128:131], v[0:3]
    ds_read_b64_tr_b16 v[60:61], v161 offset:35840
    v_mfma_f32_16x16x32_bf16 v[20:23], v[40:43], v[132:135], v[20:23]
    ds_read_b64_tr_b16 v[62:63], v162 offset:35840
    v_mfma_f32_16x16x32_bf16 v[4:7], v[44:47], v[128:131], v[4:7]
    ds_read_b64_tr_b16 v[64:65], v161 offset:35848
    v_mfma_f32_16x16x32_bf16 v[24:27], v[44:47], v[132:135], v[24:27]
    ds_read_b64_tr_b16 v[66:67], v162 offset:35848
    s_waitcnt lgkmcnt(6)
    v_mfma_f32_16x16x32_bf16 v[8:11], v[48:51], v[128:131], v[8:11]
    ds_read_b64_tr_b16 v[68:69], v161 offset:35856
    v_mfma_f32_16x16x32_bf16 v[28:31], v[48:51], v[132:135], v[28:31]
    ds_read_b64_tr_b16 v[70:71], v162 offset:35856
    v_mfma_f32_16x16x32_bf16 v[12:15], v[52:55], v[128:131], v[12:15]
    ds_read_b64_tr_b16 v[72:73], v161 offset:35864
    v_mfma_f32_16x16x32_bf16 v[32:35], v[52:55], v[132:135], v[32:35]
    ds_read_b64_tr_b16 v[74:75], v162 offset:35864
    s_waitcnt lgkmcnt(8)
    v_mfma_f32_16x16x32_bf16 v[16:19], v[56:59], v[128:131], v[16:19]
    ds_read_b64_tr_b16 v[76:77], v161 offset:35872
    v_mfma_f32_16x16x32_bf16 v[36:39], v[56:59], v[132:135], v[36:39]
    ds_read_b64_tr_b16 v[78:79], v162 offset:35872
    s_waitcnt vmcnt(0)
L_chk7:
    v_max3_u32 v40, v136, v137, v138
    v_max3_u32 v40, v40, v139, v140
    v_max3_u32 v40, v40, v141, v142
    v_max3_u32 v40, v40, v143, v144
    v_max3_u32 v40, v40, v145, v146
    v_max3_u32 v40, v40, v147, v148
    v_max3_u32 v40, v40, v149, v150
    v_max3_u32 v40, v40, v151, v152
    v_max3_u32 v40, v40, v153, v154
    v_max3_u32 v40, v40, v155, v156
    v_max3_u32 v40, v40, v157, v158
    v_max_u32 v40, v40, v159
    v_cmp_eq_u32 vcc, -1, v40
    s_nop 4
    s_cbranch_vccnz L_retry7
L_ok7:
    v_add_u32 v161, s29, v163
    v_add_u32 v162, s29, v164
    s_waitcnt lgkmcnt(6)
    v_mfma_f32_16x16x32_bf16 v[0:3], v[60:63], v[136:139], v[0:3]
    ds_read_b64_tr_b16 v[40:41], v161 offset:0
    v_mfma_f32_16x16x32_bf16 v[20:23], v[60:63], v[140:143], v[20:23]
    ds_read_b64_tr_b16 v[42:43], v162 offset:0
    v_mfma_f32_16x16x32_bf16 v[4:7], v[64:67], v[136:139], v[4:7]
    ds_read_b64_tr_b16 v[44:45], v161 offset:8
    v_mfma_f32_16x16x32_bf16 v[24:27], v[64:67], v[140:143], v[24:27]
    ds_read_b64_tr_b16 v[46:47], v162 offset:8
    s_waitcnt lgkmcnt(6)
    v_mfma_f32_16x16x32_bf16 v[8:11], v[68:71], v[136:139], v[8:11]
    ds_read_b64_tr_b16 v[48:49], v161 offset:16
    v_mfma_f32_16x16x32_bf16 v[28:31], v[68:71], v[140:143], v[28:31]
    ds_read_b64_tr_b16 v[50:51], v162 offset:16
    v_mfma_f32_16x16x32_bf16 v[12:15], v[72:75], v[136:139], v[12:15]
    ds_read_b64_tr_b16 v[52:53], v161 offset:24
    v_mfma_f32_16x16x32_bf16 v[32:35], v[72:75], v[140:143], v[32:35]
    ds_read_b64_tr_b16 v[54:55], v162 offset:24
    s_waitcnt lgkmcnt(8)
    v_mfma_f32_16x16x32_bf16 v[16:19], v[76:79], v[136:139], v[16:19]
    ds_read_b64_tr_b16 v[56:57], v161 offset:32
    v_mfma_f32_16x16x32_bf16 v[36:39], v[76:79], v[140:143], v[36:39]
    ds_read_b64_tr_b16 v[58:59], v162 offset:32
    s_waitcnt lgkmcnt(6)
    v_mfma_f32_16x16x32_bf16 v[0:3], v[40:43], v[144:147], v[0:3]
    ds_read_b64_tr_b16 v[60:61], v161 offset:5120
    v_mfma_f32_16x16x32_bf16 v[20:23], v[40:43], v[148:151], v[20:23]
    ds_read_b64_tr_b16 v[62:63], v162 offset:5120
    v_mfma_f32_16x16x32_bf16 v[4:7], v[44:47], v[144:147], v[4:7]
    ds_read_b64_tr_b16 v[64:65], v161 offset:5128
    v_mfma_f32_16x16x32_bf16 v[24:27], v[44:47], v[148:151], v[24:27]
    ds_read_b64_tr_b16 v[66:67], v162 offset:5128
    s_waitcnt lgkmcnt(6)
    v_mfma_f32_16x16x32_bf16 v[8:11], v[48:51], v[144:147], v[8:11]
    ds_read_b64_tr_b16 v[68:69], v161 offset:5136
    v_mfma_f32_16x16x32_bf16 v[28:31], v[48:51], v[148:151], v[28:31]
    ds_read_b64_tr_b16 v[70:71], v162 offset:5136
    v_mfma_f32_16x16x32_bf16 v[12:15], v[52:55], v[144:147], v[12:15]
    ds_read_b64_tr_b16 v[72:73], v161 offset:5144
    v_mfma_f32_16x16x32_bf16 v[32:35], v[52:55], v[148:151], v[32:35]
    ds_read_b64_tr_b16 v[74:75], v162 offset:5144
    s_waitcnt lgkmcnt(8)
    v_mfma_f32_16x16x32_bf16 v[16:19], v[56:59], v[144:147], v[16:19]
    ds_read_b64_tr_b16 v[76:77], v161 offset:5152
    v_mfma_f32_16x16x32_bf16 v[36:39], v[56:59], v[148:151], v[36:39]
    ds_read_b64_tr_b16 v[78:79], v162 offset:5152
    s_waitcnt lgkmcnt(6)
    v_mfma_f32_16x16x32_bf16 v[0:3], v[60:63], v[152:155], v[0:3]
    v_mfma_f32_16x16x32_bf16 v[20:23], v[60:63], v[156:159], v[20:23]
    v_mfma_f32_16x16x32_bf16 v[4:7], v[64:67], v[152:155], v[4:7]
    v_mfma_f32_16x16x32_bf16 v[24:27], v[64:67], v[156:159], v[24:27]
    s_waitcnt lgkmcnt(2)
    v_mfma_f32_16x16x32_bf16 v[8:11], v[68:71], v[152:155], v[8:11]
    v_mfma_f32_16x16x32_bf16 v[28:31], v[68:71], v[156:159], v[28:31]
    v_mfma_f32_16x16x32_bf16 v[12:15], v[72:75], v[152:155], v[12:15]
    v_mfma_f32_16x16x32_bf16 v[32:35], v[72:75], v[156:159], v[32:35]
    s_waitcnt lgkmcnt(0)
    v_mfma_f32_16x16x32_bf16 v[16:19], v[76:79], v[152:155], v[16:19]
    v_mfma_f32_16x16x32_bf16 v[36:39], v[76:79], v[156:159], v[36:39]
    ds_read_b128 v[40:43], v166 offset:0
    ds_read_b128 v[44:47], v166 offset:1024
    ds_read_b128 v[48:51], v166 offset:2048
    ds_read_b128 v[52:55], v166 offset:3072
    ds_read_b128 v[56:59], v166 offset:4096
    v_lshlrev_b32 v102, 4, v167
    v_add_u32 v102, s24, v102
    v_and_b32 v100, 15, v167
    v_lshrrev_b32 v101, 4, v167
    v_mul_u32_u24 v100, 1280, v100
    v_mad_u32_u24 v100, v101, 40, v100
    s_mul_i32 s3, s18, 1280
    s_mul_i32 s95, s63, 160
    s_add_u32 s3, s3, s95
    ds_write_b128 v102, v[20:23] offset:20480
    ds_write_b128 v102, v[24:27] offset:21504
    ds_write_b128 v102, v[28:31] offset:22528
    ds_write_b128 v102, v[32:35] offset:23552
    ds_write_b128 v102, v[36:39] offset:24576
    s_waitcnt lgkmcnt(0)
    s_barrier
    ds_read_b128 v[60:63], v166 offset:20480
    ds_read_b128 v[64:67], v166 offset:21504
    ds_read_b128 v[68:71], v166 offset:22528
    ds_read_b128 v[72:75], v166 offset:23552
    ds_read_b128 v[76:79], v166 offset:24576
    v_fma_f32 v40, v0, v160, v40
    v_fma_f32 v41, v1, v160, v41
    v_fma_f32 v42, v2, v160, v42
    v_fma_f32 v43, v3, v160, v43
    v_fma_f32 v44, v4, v160, v44
    v_fma_f32 v45, v5, v160, v45
    v_fma_f32 v46, v6, v160, v46
    v_fma_f32 v47, v7, v160, v47
    v_fma_f32 v48, v8, v160, v48
    v_fma_f32 v49, v9, v160, v49
    v_fma_f32 v50, v10, v160, v50
    v_fma_f32 v51, v11, v160, v51
    v_fma_f32 v52, v12, v160, v52
    v_fma_f32 v53, v13, v160, v53
    v_fma_f32 v54, v14, v160, v54
    v_fma_f32 v55, v15, v160, v55
    v_fma_f32 v56, v16, v160, v56
    v_fma_f32 v57, v17, v160, v57
    v_fma_f32 v58, v18, v160, v58
    v_fma_f32 v59, v19, v160, v59
    s_waitcnt lgkmcnt(0)
    v_fma_f32 v40, v60, v160, v40
    v_fma_f32 v41, v61, v160, v41
    v_fma_f32 v42, v62, v160, v42
    v_fma_f32 v43, v63, v160, v43
    v_fma_f32 v44, v64, v160, v44
    v_fma_f32 v45, v65, v160, v45
    v_fma_f32 v46, v66, v160, v46
    v_fma_f32 v47, v67, v160, v47
    v_fma_f32 v48, v68, v160, v48
    v_fma_f32 v49, v69, v160, v49
    v_fma_f32 v50, v70, v160, v50
    v_fma_f32 v51, v71, v160, v51
    v_fma_f32 v52, v72, v160, v52
    v_fma_f32 v53, v73, v160, v53
    v_fma_f32 v54, v74, v160, v54
    v_fma_f32 v55, v75, v160, v55
    v_fma_f32 v56, v76, v160, v56
    v_fma_f32 v57, v77, v160, v57
    v_fma_f32 v58, v78, v160, v58
    v_fma_f32 v59, v79, v160, v59
    v_cvt_pk_bf16_f32 v0, v40, v41
    v_cvt_pk_bf16_f32 v1, v42, v43
    v_cvt_pk_bf16_f32 v2, v44, v45
    v_cvt_pk_bf16_f32 v3, v46, v47
    v_cvt_pk_bf16_f32 v4, v48, v49
    v_cvt_pk_bf16_f32 v5, v50, v51
    v_cvt_pk_bf16_f32 v6, v52, v53
    v_cvt_pk_bf16_f32 v7, v54, v55
    v_cvt_pk_bf16_f32 v8, v56, v57
    v_cvt_pk_bf16_f32 v9, v58, v59
    buffer_store_dwordx4 v[0:3], v100, s[32:35], s3 offen
    buffer_store_dwordx4 v[4:7], v100, s[32:35], s3 offen offset:16
    buffer_store_dwordx2 v[8:9], v100, s[32:35], s3 offen offset:32
    s_branch L_end
L_retry0:
    s_sub_u32 s10, s10, 1
    s_cmp_eq_u32 s10, 0
    s_cbranch_scc1 L_ok0
    v_xor_b32 v62, 0x100, v165
    v_lshrrev_b32 v60, 4, v167
    v_lshlrev_b32 v60, 9, v60
    v_and_b32 v61, 0x1ff, v165
    v_lshrrev_b32 v61, 1, v61
    v_add_u32 v60, v60, v61
    v_xor_b32 v61, 0x80, v60
    s_add_u32 s4, s26, 0
    buffer_load_dwordx4 v[80:83], v165, s[56:59], s4 offen offset:0 sc1
    buffer_load_dwordx4 v[84:87], v62, s[56:59], s4 offen offset:0 sc1
    s_waitcnt vmcnt(0)
    s_branch L_chk0
L_retry1:
    s_sub_u32 s10, s10, 1
    s_cmp_eq_u32 s10, 0
    s_cbranch_scc1 L_ok1
    v_xor_b32 v42, 0x100, v165
    v_lshrrev_b32 v40, 4, v167
    v_lshlrev_b32 v40, 9, v40
    v_and_b32 v41, 0x1ff, v165
    v_lshrrev_b32 v41, 1, v41
    v_add_u32 v40, v40, v41
    v_xor_b32 v41, 0x80, v40
    s_add_u32 s4, s26, 0
    buffer_load_dwordx4 v[88:91], v165, s[56:59], s4 offen offset:2048 sc1
    buffer_load_dwordx4 v[92:95], v42, s[56:59], s4 offen offset:2048 sc1
    s_add_u32 s4, s26, 4096
    buffer_load_dwordx4 v[96:99], v165, s[56:59], s4 offen offset:0 sc1
    buffer_load_dwordx4 v[100:103], v42, s[56:59], s4 offen offset:0 sc1
    s_waitcnt vmcnt(0)
    s_branch L_chk1
L_retry3:
    s_sub_u32 s10, s10, 1
    s_cmp_eq_u32 s10, 0
    s_cbranch_scc1 L_ok3
    v_xor_b32 v42, 0x100, v165
    v_lshrrev_b32 v40, 4, v167
    v_lshlrev_b32 v40, 9, v40
    v_and_b32 v41, 0x1ff, v165
    v_lshrrev_b32 v41, 1, v41
    v_add_u32 v40, v40, v41
    v_xor_b32 v41, 0x80, v40
    s_add_u32 s4, s26, 4096
    buffer_load_dwordx4 v[104:107], v165, s[56:59], s4 offen offset:2048 sc1
    buffer_load_dwordx4 v[108:111], v42, s[56:59], s4 offen offset:2048 sc1
    s_add_u32 s4, s26, 8192
    buffer_load_dwordx4 v[112:115], v165, s[56:59], s4 offen offset:0 sc1
    buffer_load_dwordx4 v[116:119], v42, s[56:59], s4 offen offset:0 sc1
    s_waitcnt vmcnt(0)
    s_branch L_chk3
L_retry5:
    s_sub_u32 s10, s10, 1
    s_cmp_eq_u32 s10, 0
    s_cbranch_scc1 L_ok5
    v_xor_b32 v42, 0x100, v165
    v_lshrrev_b32 v40, 4, v167
    v_lshlrev_b32 v40, 9, v40
    v_and_b32 v41, 0x1ff, v165
    v_lshrrev_b32 v41, 1, v41
    v_add_u32 v40, v40, v41
    v_xor_b32 v41, 0x80, v40
    s_add_u32 s4, s26, 8192
    buffer_load_dwordx4 v[120:123], v165, s[56:59], s4 offen offset:2048 sc1
    buffer_load_dwordx4 v[124:127], v42, s[56:59], s4 offen offset:2048 sc1
    s_add_u32 s4, s26, 12288
    buffer_load_dwordx4 v[128:131], v165, s[56:59], s4 offen offset:0 sc1
    buffer_load_dwordx4 v[132:135], v42, s[56:59], s4 offen offset:0 sc1
    s_waitcnt vmcnt(0)
    s_branch L_chk5
L_retry7:
    s_sub_u32 s10, s10, 1
    s_cmp_eq_u32 s10, 0
    s_cbranch_scc1 L_ok7
    v_xor_b32 v42, 0x100, v165
    v_lshrrev_b32 v40, 4, v167
    v_lshlrev_b32 v40, 9, v40
    v_and_b32 v41, 0x1ff, v165
    v_lshrrev_b32 v41, 1, v41
    v_add_u32 v40, v40, v41
    v_xor_b32 v41, 0x80, v40
    s_add_u32 s4, s26, 12288
    buffer_load_dwordx4 v[136:139], v165, s[56:59], s4 offen offset:2048 sc1
    buffer_load_dwordx4 v[140:143], v42, s[56:59], s4 offen offset:2048 sc1
    buffer_load_dwordx2 v[144:145], v40, s[56:59], s27 offen offset:0 sc1
    buffer_load_dwordx2 v[146:147], v40, s[56:59], s27 offen offset:256 sc1
    buffer_load_dwordx2 v[148:149], v41, s[56:59], s27 offen offset:0 sc1
    buffer_load_dwordx2 v[150:151], v41, s[56:59], s27 offen offset:256 sc1
    buffer_load_dwordx2 v[152:153], v40, s[56:59], s27 offen offset:2048 sc1
    buffer_load_dwordx2 v[154:155], v40, s[56:59], s27 offen offset:2304 sc1
    buffer_load_dwordx2 v[156:157], v41, s[56:59], s27 offen offset:2048 sc1
    buffer_load_dwordx2 v[158:159], v41, s[56:59], s27 offen offset:2304 sc1
    s_waitcnt vmcnt(0)
    s_branch L_chk7
    s_branch L_end
L_awave:
    s_waitcnt lgkmcnt(0)
    s_load_dwordx4 s[44:47], s[0:1], 0
    s_load_dwordx2 s[4:5], s[0:1], 80
    s_load_dwordx2 s[8:9], s[0:1], 40
    s_load_dwordx2 s[52:53], s[0:1], 32
    s_load_dwordx2 s[56:57], s[0:1], 48
    s_load_dwordx2 s[60:61], s[0:1], 16
    s_and_b32 s15, s14, 3
    s_lshr_b32 s16, s14, 2
    s_lshr_b32 s37, s2, 3
    s_lshl_b32 s37, s37, 3
    s_add_u32 s37, s37, s14
    v_and_b32 v103, 63, v0
    v_mov_b32 v80, v103
    v_and_b32 v81, 31, v80
    v_lshrrev_b32 v82, 5, v80
    v_lshlrev_b32 v163, 4, v80
    v_lshlrev_b32 v164, 5, v81
    v_lshl_add_u32 v164, v82, 4, v164
    v_bfe_u32 v83, v81, 1, 3
    v_xor_b32 v83, v83, v82
    v_lshlrev_b32 v83, 4, v83
    v_lshl_add_u32 v159, v81, 7, v83
    s_lshl_b32 s17, s15, 12
    v_add_u32 v159, s17, v159
    v_bfe_u32 v83, v80, 2, 2
    v_lshl_add_u32 v84, v82, 3, v83
    v_bfe_u32 v85, v80, 4, 1
    v_and_b32 v86, 3, v80
    v_and_b32 v87, 1, v80
    v_lshlrev_b32 v87, 1, v87
    v_bfe_u32 v88, v80, 1, 1
    v_add_u32 v87, v87, v88
    v_lshlrev_b32 v91, 3, v86
    v_lshlrev_b32 v85, 5, v85
    v_lshl_add_u32 v87, v87, 3, v85
    v_min_u32 v92, 1, v86
    v_lshl_add_u32 v86, v86, 3, v85
    v_lshlrev_b32 v88, 8, v84
    v_add_u32 v88, 16384, v88
    s_lshl_b32 s17, s16, 1
    v_xor_b32 v89, s17, v83
    v_lshl_add_u32 v160, v89, 6, v88
    v_xor_b32 v89, 1, v89
    v_lshl_add_u32 v161, v89, 6, v88
    v_add_u32 v160, v160, v87
    s_cmp_eq_u32 s16, 0
    s_cselect_b64 vcc, -1, 0
    v_mul_u32_u24 v90, 192, v84
    v_cndmask_b32 v86, v86, v87, vcc
    v_add_u32 v161, v161, v86
    s_lshl_b32 s17, s16, 7
    s_add_u32 s17, s17, 16384
    v_add3_u32 v162, v90, v87, s17
    s_lshl_b32 s24, s16, 12
    v_add_u32 v139, s24, v163
    s_lshl_b32 s24, s16, 10
    s_add_u32 s24, s24, 8192
    v_lshl_add_u32 v140, v80, 3, s24
    v_mov_b32 v94, 159808
    v_cmp_eq_u32 vcc, 0, v82
    v_lshl_add_u32 v93, v82, 2, v83
    v_mul_u32_u24 v93, 48, v93
    v_cndmask_b32 v140, v94, v140, vcc
    v_xor_b32 v142, 1, v82
    v_lshl_add_u32 v92, v92, 3, 32
    v_cmp_eq_u32 vcc, 0, v85
    s_and_b32 s40, s2, 7
    s_lshl_b32 s40, s40, 2
    s_bfe_u32 s41, s2, 0x20003
    v_cndmask_b32 v91, v92, v91, vcc
    s_add_u32 s40, s40, s41
    s_lshr_b32 s41, s2, 5
    s_mul_i32 s24, s16, 6144
    s_add_u32 s24, s24, 10240
    v_add3_u32 v141, v93, v91, s24
    s_lshl_b32 s26, s15, 1
    s_add_u32 s26, s26, s16
    s_lshl_b32 s25, s41, 3
    s_add_u32 s25, s25, s26
    s_mul_i32 s29, s25, 40960
    s_add_u32 s29, s29, 8388608
    s_lshl_b32 s30, s40, 10
    s_add_u32 s30, s30, s29
    v_add_u32 v151, s30, v163
    s_lshl_b32 s30, s40, 8
    s_add_u32 s30, s30, s29
    s_add_u32 s30, s30, 32768
    v_lshl_add_u32 v152, v81, 3, s30
    s_lshl_b32 s30, s26, 10
    s_add_u32 s30, s30, 22528
    v_add_u32 v148, s30, v163
    s_xor_b32 s27, s26, 1
    s_lshl_b32 s30, s27, 10
    s_add_u32 s30, s30, 22528
    v_add_u32 v150, s30, v163
    s_lshl_b32 s30, s26, 8
    s_add_u32 s30, s30, 30720
    v_lshl_add_u32 v149, v81, 3, s30
    s_lshl_b32 s30, s27, 8
    s_add_u32 s30, s30, 30720
    v_lshl_add_u32 v165, v81, 3, s30
    v_and_b32 v81, 15, v80
    v_lshrrev_b32 v89, 4, v80
    v_bfe_u32 v90, v81, 1, 3
    v_xor_b32 v90, v90, v89
    v_lshlrev_b32 v90, 4, v90
    v_lshl_add_u32 v159, v81, 7, v90
    s_lshl_b32 s17, s15, 12
    v_add_u32 v159, s17, v159
    v_lshl_add_u32 v84, v89, 3, v83
    v_and_b32 v85, 1, v89
    v_and_b32 v86, 3, v80
    v_lshlrev_b32 v86, 3, v86
    v_lshl_add_u32 v86, v85, 5, v86
    v_lshlrev_b32 v88, 8, v84
    v_add3_u32 v88, v88, v86, 0
    v_add_u32 v88, 16384, v88
    s_lshl_b32 s17, s16, 1
    v_xor_b32 v90, s17, v83
    v_lshl_add_u32 v160, v90, 6, v88
    v_xor_b32 v90, 1, v90
    v_lshl_add_u32 v161, v90, 6, v88
    v_mul_u32_u24 v90, 192, v84
    s_lshl_b32 s17, s16, 7
    s_add_u32 s17, s17, 16384
    v_add3_u32 v162, v90, v86, s17
    v_lshrrev_b32 v90, 1, v89
    v_lshlrev_b32 v91, 4, v81
    v_lshl_add_u32 v92, v85, 9, v91
    v_lshl_add_u32 v131, v90, 16, v92
    v_mul_u32_u24 v90, 180224, v90
    v_add_u32 v132, v90, v92
    v_lshlrev_b32 v92, 5, v81
    v_lshl_add_u32 v92, v85, 4, v92
    v_add_u32 v164, v90, v92
    v_lshl_add_u32 v167, v89, 9, v91
    v_lshlrev_b32 v133, 3, v89
    s_lshl_b32 s23, s12, 2
    s_add_u32 s23, s23, s15
    s_lshl_b32 s28, s23, 10
    s_add_u32 s28, s28, 0
    s_lshr_b32 s29, s23, 3
    s_mul_i32 s29, s29, 22528
    s_add_u32 s29, s29, 2621440
    s_and_b32 s34, s23, 7
    s_lshl_b32 s31, s34, 10
    s_add_u32 s32, s31, 10240
    s_lshl_b32 s42, s34, 9
    s_add_u32 s42, s42, 18432
    s_lshl_b32 s34, s34, 8
    s_add_u32 s34, s34, 8192
    s_lshl_b32 s33, s23, 8
    s_add_u32 s33, s33, 2097152
    s_mov_b32 s30, 0x3ea52b5c
    s_mov_b32 s35, 0x42200000
    s_mul_i32 s36, s13, 192
    s_lshl_b32 s17, s16, 7
    s_add_u32 s36, s36, s17
    v_lshlrev_b32 v82, 4, v82
    s_mov_b32 s18, 0
    s_waitcnt lgkmcnt(0)
    s_mov_b32 s6, 22829312
    s_mov_b32 s7, 0x20000
    s_mov_b32 s10, 3072
    s_mov_b32 s11, 0x20000
    s_mov_b32 s44, 0x3fb8aa3b
    s_mov_b32 s45, s44
    s_mov_b32 s46, 2.0
    s_mov_b32 s47, 2.0
    buffer_load_dword v134, v133, s[8:11], s36 offen
    v_mov_b32 v0, 0
    v_mov_b32 v1, 0
    v_mov_b32 v2, 0
    v_mov_b32 v3, 0
    v_mov_b32 v4, 0
    v_mov_b32 v5, 0
    v_mov_b32 v6, 0
    v_mov_b32 v7, 0
    v_mov_b32 v8, 0
    v_mov_b32 v9, 0
    v_mov_b32 v10, 0
    v_mov_b32 v11, 0
    v_mov_b32 v12, 0
    v_mov_b32 v13, 0
    v_mov_b32 v14, 0
    v_mov_b32 v15, 0
    v_mov_b32 v16, 0
    v_mov_b32 v17, 0
    v_mov_b32 v18, 0
    v_mov_b32 v19, 0
    v_mov_b32 v20, 0
    v_mov_b32 v21, 0
    v_mov_b32 v22, 0
    v_mov_b32 v23, 0
    v_mov_b32 v24, 0
    v_mov_b32 v25, 0
    v_mov_b32 v26, 0
    v_mov_b32 v27, 0
    v_mov_b32 v28, 0
    v_mov_b32 v29, 0
    v_mov_b32 v30, 0
    v_mov_b32 v31, 0
    s_cmp_lg_u32 s16, 0
    s_cbranch_scc1 L_hi
    v_add_u32 v153, s18, v159
    v_add_u32 v157, s18, v160
    v_add_u32 v158, s18, v161
    v_xor_b32 v154, 64, v153
    v_xor_b32 v128, 32, v157
    v_xor_b32 v129, 32, v158
    s_mov_b32 s43, s18
    s_add_u32 s18, s18, 32768
    s_cmp_eq_u32 s18, 163840
    s_cselect_b32 s18, 0, s18
    s_mov_b32 s19, 1
    s_barrier
    ds_read_b128 v[32:35], v153 offset:0
    ds_read_b64_tr_b16 v[36:37], v157 offset:0
    ds_read_b64_tr_b16 v[38:39], v157 offset:1024
    ds_read_b64_tr_b16 v[40:41], v158 offset:0
    ds_read_b64_tr_b16 v[42:43], v158 offset:1024
    ds_read_b128 v[44:47], v153 offset:2048
    ds_read_b64_tr_b16 v[48:49], v128 offset:0
    ds_read_b64_tr_b16 v[50:51], v128 offset:1024
    ds_read_b64_tr_b16 v[52:53], v129 offset:0
    ds_read_b64_tr_b16 v[54:55], v129 offset:1024
    ds_read_b128 v[56:59], v154 offset:0
    ds_read_b64_tr_b16 v[60:61], v157 offset:8192
    ds_read_b64_tr_b16 v[62:63], v157 offset:9216
    ds_read_b64_tr_b16 v[64:65], v158 offset:8192
    ds_read_b64_tr_b16 v[66:67], v158 offset:9216
    ds_read_b128 v[68:71], v154 offset:2048
    ds_read_b64_tr_b16 v[72:73], v128 offset:8192
    ds_read_b64_tr_b16 v[74:75], v128 offset:9216
    ds_read_b64_tr_b16 v[76:77], v129 offset:8192
    ds_read_b64_tr_b16 v[78:79], v129 offset:9216
    v_add_u32 v153, s18, v159
    v_add_u32 v157, s18, v160
    v_add_u32 v158, s18, v161
    v_xor_b32 v154, 64, v153
    v_xor_b32 v128, 32, v157
    v_xor_b32 v129, 32, v158
    s_mov_b32 s43, s18
    s_add_u32 s18, s18, 32768
    s_cmp_eq_u32 s18, 163840
    s_cselect_b32 s18, 0, s18
    s_add_u32 s19, s19, 1
    s_waitcnt lgkmcnt(0)
    s_barrier
L_p1lo:
    v_mfma_f32_16x16x32_bf16 v[0:3], v[36:39], v[32:35], v[0:3]
    v_mfma_f32_16x16x32_bf16 v[8:11], v[36:39], v[44:47], v[8:11]
    ds_read_b128 v[80:83], v153 offset:0
    ds_read_b64_tr_b16 v[84:85], v157 offset:0
    ds_read_b64_tr_b16 v[86:87], v157 offset:1024
    v_mfma_f32_16x16x32_bf16 v[16:19], v[40:43], v[32:35], v[16:19]
    v_mfma_f32_16x16x32_bf16 v[24:27], v[40:43], v[44:47], v[24:27]
    ds_read_b64_tr_b16 v[88:89], v158 offset:0
    ds_read_b64_tr_b16 v[90:91], v158 offset:1024
    ds_read_b128 v[92:95], v153 offset:2048
    v_mfma_f32_16x16x32_bf16 v[4:7], v[48:51], v[32:35], v[4:7]
    v_mfma_f32_16x16x32_bf16 v[12:15], v[48:51], v[44:47], v[12:15]
    ds_read_b64_tr_b16 v[96:97], v128 offset:0
    ds_read_b64_tr_b16 v[98:99], v128 offset:1024
    ds_read_b64_tr_b16 v[100:101], v129 offset:0
    v_mfma_f32_16x16x32_bf16 v[20:23], v[52:55], v[32:35], v[20:23]
    v_mfma_f32_16x16x32_bf16 v[28:31], v[52:55], v[44:47], v[28:31]
    ds_read_b64_tr_b16 v[102:103], v129 offset:1024
    ds_read_b128 v[104:107], v154 offset:0
    ds_read_b64_tr_b16 v[108:109], v157 offset:8192
    v_mfma_f32_16x16x32_bf16 v[0:3], v[60:63], v[56:59], v[0:3]
    v_mfma_f32_16x16x32_bf16 v[8:11], v[60:63], v[68:71], v[8:11]
    ds_read_b64_tr_b16 v[110:111], v157 offset:9216
    ds_read_b64_tr_b16 v[112:113], v158 offset:8192
    ds_read_b64_tr_b16 v[114:115], v158 offset:9216
    v_mfma_f32_16x16x32_bf16 v[16:19], v[64:67], v[56:59], v[16:19]
    v_mfma_f32_16x16x32_bf16 v[24:27], v[64:67], v[68:71], v[24:27]
    ds_read_b128 v[116:119], v154 offset:2048
    ds_read_b64_tr_b16 v[120:121], v128 offset:8192
    ds_read_b64_tr_b16 v[122:123], v128 offset:9216
    v_mfma_f32_16x16x32_bf16 v[4:7], v[72:75], v[56:59], v[4:7]
    v_mfma_f32_16x16x32_bf16 v[12:15], v[72:75], v[68:71], v[12:15]
    ds_read_b64_tr_b16 v[124:125], v129 offset:8192
    ds_read_b64_tr_b16 v[126:127], v129 offset:9216
    v_add_u32 v153, s18, v159
    v_add_u32 v157, s18, v160
    v_add_u32 v158, s18, v161
    v_xor_b32 v154, 64, v153
    v_xor_b32 v128, 32, v157
    v_xor_b32 v129, 32, v158
    s_mov_b32 s43, s18
    s_add_u32 s18, s18, 32768
    s_cmp_eq_u32 s18, 163840
    s_cselect_b32 s18, 0, s18
    v_mfma_f32_16x16x32_bf16 v[20:23], v[76:79], v[56:59], v[20:23]
    v_mfma_f32_16x16x32_bf16 v[28:31], v[76:79], v[68:71], v[28:31]
    s_cmp_eq_u32 s19, 10
    s_cbranch_scc1 L_p1lo_last
    s_add_u32 s19, s19, 1
    s_waitcnt lgkmcnt(0)
    s_barrier
    v_mfma_f32_16x16x32_bf16 v[0:3], v[84:87], v[80:83], v[0:3]
    v_mfma_f32_16x16x32_bf16 v[8:11], v[84:87], v[92:95], v[8:11]
    ds_read_b128 v[32:35], v153 offset:0
    ds_read_b64_tr_b16 v[36:37], v157 offset:0
    ds_read_b64_tr_b16 v[38:39], v157 offset:1024
    v_mfma_f32_16x16x32_bf16 v[16:19], v[88:91], v[80:83], v[16:19]
    v_mfma_f32_16x16x32_bf16 v[24:27], v[88:91], v[92:95], v[24:27]
    ds_read_b64_tr_b16 v[40:41], v158 offset:0
    ds_read_b64_tr_b16 v[42:43], v158 offset:1024
    ds_read_b128 v[44:47], v153 offset:2048
    v_mfma_f32_16x16x32_bf16 v[4:7], v[96:99], v[80:83], v[4:7]
    v_mfma_f32_16x16x32_bf16 v[12:15], v[96:99], v[92:95], v[12:15]
    ds_read_b64_tr_b16 v[48:49], v128 offset:0
    ds_read_b64_tr_b16 v[50:51], v128 offset:1024
    ds_read_b64_tr_b16 v[52:53], v129 offset:0
    v_mfma_f32_16x16x32_bf16 v[20:23], v[100:103], v[80:83], v[20:23]
    v_mfma_f32_16x16x32_bf16 v[28:31], v[100:103], v[92:95], v[28:31]
    ds_read_b64_tr_b16 v[54:55], v129 offset:1024
    ds_read_b128 v[56:59], v154 offset:0
    ds_read_b64_tr_b16 v[60:61], v157 offset:8192
    v_mfma_f32_16x16x32_bf16 v[0:3], v[108:111], v[104:107], v[0:3]
    v_mfma_f32_16x16x32_bf16 v[8:11], v[108:111], v[116:119], v[8:11]
    ds_read_b64_tr_b16 v[62:63], v157 offset:9216
    ds_read_b64_tr_b16 v[64:65], v158 offset:8192
    ds_read_b64_tr_b16 v[66:67], v158 offset:9216
    v_mfma_f32_16x16x32_bf16 v[16:19], v[112:115], v[104:107], v[16:19]
    v_mfma_f32_16x16x32_bf16 v[24:27], v[112:115], v[116:119], v[24:27]
    ds_read_b128 v[68:71], v154 offset:2048
    ds_read_b64_tr_b16 v[72:73], v128 offset:8192
    ds_read_b64_tr_b16 v[74:75], v128 offset:9216
    v_mfma_f32_16x16x32_bf16 v[4:7], v[120:123], v[104:107], v[4:7]
    v_mfma_f32_16x16x32_bf16 v[12:15], v[120:123], v[116:119], v[12:15]
    ds_read_b64_tr_b16 v[76:77], v129 offset:8192
    ds_read_b64_tr_b16 v[78:79], v129 offset:9216
    v_add_u32 v153, s18, v159
    v_add_u32 v157, s18, v160
    v_add_u32 v158, s18, v161
    v_xor_b32 v154, 64, v153
    v_xor_b32 v128, 32, v157
    v_xor_b32 v129, 32, v158
    s_mov_b32 s43, s18
    s_add_u32 s18, s18, 32768
    s_cmp_eq_u32 s18, 163840
    s_cselect_b32 s18, 0, s18
    v_mfma_f32_16x16x32_bf16 v[20:23], v[124:127], v[104:107], v[20:23]
    v_mfma_f32_16x16x32_bf16 v[28:31], v[124:127], v[116:119], v[28:31]
    s_add_u32 s19, s19, 1
    s_waitcnt lgkmcnt(0)
    s_barrier
    s_branch L_p1lo
L_p1lo_last:
    s_mov_b32 s18, s43
    s_waitcnt lgkmcnt(0)
    buffer_load_dwordx2 v[32:33], v133, s[8:11], s36 offen offset:0
    buffer_load_dwordx2 v[34:35], v133, s[8:11], s36 offen offset:32
    buffer_load_dwordx2 v[36:37], v133, s[8:11], s36 offen offset:64
    buffer_load_dwordx2 v[38:39], v133, s[8:11], s36 offen offset:96
    v_mfma_f32_16x16x32_bf16 v[0:3], v[84:87], v[80:83], v[0:3]
    v_mfma_f32_16x16x32_bf16 v[8:11], v[84:87], v[92:95], v[8:11]
    v_mfma_f32_16x16x32_bf16 v[16:19], v[88:91], v[80:83], v[16:19]
    v_mfma_f32_16x16x32_bf16 v[24:27], v[88:91], v[92:95], v[24:27]
    v_mfma_f32_16x16x32_bf16 v[4:7], v[96:99], v[80:83], v[4:7]
    v_mfma_f32_16x16x32_bf16 v[12:15], v[96:99], v[92:95], v[12:15]
    v_mfma_f32_16x16x32_bf16 v[20:23], v[100:103], v[80:83], v[20:23]
    v_mfma_f32_16x16x32_bf16 v[28:31], v[100:103], v[92:95], v[28:31]
    v_mfma_f32_16x16x32_bf16 v[0:3], v[108:111], v[104:107], v[0:3]
    v_mfma_f32_16x16x32_bf16 v[8:11], v[108:111], v[116:119], v[8:11]
    v_mfma_f32_16x16x32_bf16 v[16:19], v[112:115], v[104:107], v[16:19]
    v_mfma_f32_16x16x32_bf16 v[24:27], v[112:115], v[116:119], v[24:27]
    v_mfma_f32_16x16x32_bf16 v[4:7], v[120:123], v[104:107], v[4:7]
    v_mfma_f32_16x16x32_bf16 v[12:15], v[120:123], v[116:119], v[12:15]
    v_mfma_f32_16x16x32_bf16 v[20:23], v[124:127], v[104:107], v[20:23]
    v_mfma_f32_16x16x32_bf16 v[28:31], v[124:127], v[116:119], v[28:31]
    s_nop 7
    s_mul_i32 s20, s13, 3
    s_add_u32 s20, s20, 0
    s_and_b32 s21, s20, 15
    s_lshr_b32 s20, s20, 4
    s_lshl_b32 s21, s21, 1
    s_cmp_lg_u32 s20, 0
    s_cbranch_scc1 L_akv
    v_mul_f32 v0, s30, v0
    v_mul_f32 v1, s30, v1
    v_mul_f32 v2, s30, v2
    v_mul_f32 v3, s30, v3
    v_mul_f32 v4, s30, v4
    v_mul_f32 v5, s30, v5
    v_mul_f32 v6, s30, v6
    v_mul_f32 v7, s30, v7
    v_mul_f32 v8, s30, v8
    v_mul_f32 v9, s30, v9
    v_mul_f32 v10, s30, v10
    v_mul_f32 v11, s30, v11
    v_mul_f32 v12, s30, v12
    v_mul_f32 v13, s30, v13
    v_mul_f32 v14, s30, v14
    v_mul_f32 v15, s30, v15
    v_cvt_pk_bf16_f32 v80, v0, v1
    v_cvt_pk_bf16_f32 v81, v2, v3
    v_cvt_pk_bf16_f32 v82, v4, v5
    v_cvt_pk_bf16_f32 v83, v6, v7
    v_cvt_pk_bf16_f32 v84, v8, v9
    v_cvt_pk_bf16_f32 v85, v10, v11
    v_cvt_pk_bf16_f32 v86, v12, v13
    v_cvt_pk_bf16_f32 v87, v14, v15
    s_lshl_b32 s21, s21, 16
    s_add_u32 s21, s21, s28
    buffer_store_dwordx4 v[80:83], v131, s[4:7], s21 offen sc1
    buffer_store_dwordx4 v[84:87], v131, s[4:7], s21 offen offset:256 sc1
    s_branch L_adone
L_akv:
    v_cvt_pk_bf16_f32 v80, v0, v1
    v_cvt_pk_bf16_f32 v81, v2, v3
    v_cvt_pk_bf16_f32 v82, v4, v5
    v_cvt_pk_bf16_f32 v83, v6, v7
    v_cvt_pk_bf16_f32 v84, v8, v9
    v_cvt_pk_bf16_f32 v85, v10, v11
    v_cvt_pk_bf16_f32 v86, v12, v13
    v_cvt_pk_bf16_f32 v87, v14, v15
    s_mul_i32 s21, s21, 180224
    s_add_u32 s21, s21, s29
    s_cmp_lg_u32 s20, 1
    s_cbranch_scc1 L_av
    s_add_u32 s21, s21, s31
    buffer_store_dwordx4 v[80:83], v132, s[4:7], s21 offen sc1
    buffer_store_dwordx4 v[84:87], v132, s[4:7], s21 offen offset:256 sc1
    s_branch L_adone
L_av:
    s_add_u32 s21, s21, s32
    buffer_store_dwordx4 v[80:83], v164, s[4:7], s21 offen sc1
    buffer_store_dwordx4 v[84:87], v164, s[4:7], s21 offen offset:512 sc1
L_adone:
    s_mul_i32 s20, s13, 3
    s_add_u32 s20, s20, 1
    s_and_b32 s21, s20, 15
    s_lshr_b32 s20, s20, 4
    s_lshl_b32 s21, s21, 1
    s_cmp_lg_u32 s20, 0
    s_cbranch_scc1 L_bkv
    v_mul_f32 v16, s30, v16
    v_mul_f32 v17, s30, v17
    v_mul_f32 v18, s30, v18
    v_mul_f32 v19, s30, v19
    v_mul_f32 v20, s30, v20
    v_mul_f32 v21, s30, v21
    v_mul_f32 v22, s30, v22
    v_mul_f32 v23, s30, v23
    v_mul_f32 v24, s30, v24
    v_mul_f32 v25, s30, v25
    v_mul_f32 v26, s30, v26
    v_mul_f32 v27, s30, v27
    v_mul_f32 v28, s30, v28
    v_mul_f32 v29, s30, v29
    v_mul_f32 v30, s30, v30
    v_mul_f32 v31, s30, v31
    v_cvt_pk_bf16_f32 v88, v16, v17
    v_cvt_pk_bf16_f32 v89, v18, v19
    v_cvt_pk_bf16_f32 v90, v20, v21
    v_cvt_pk_bf16_f32 v91, v22, v23
    v_cvt_pk_bf16_f32 v92, v24, v25
    v_cvt_pk_bf16_f32 v93, v26, v27
    v_cvt_pk_bf16_f32 v94, v28, v29
    v_cvt_pk_bf16_f32 v95, v30, v31
    s_lshl_b32 s21, s21, 16
    s_add_u32 s21, s21, s28
    buffer_store_dwordx4 v[88:91], v131, s[4:7], s21 offen sc1
    buffer_store_dwordx4 v[92:95], v131, s[4:7], s21 offen offset:256 sc1
    s_branch L_bdone
L_bkv:
    v_cvt_pk_bf16_f32 v88, v16, v17
    v_cvt_pk_bf16_f32 v89, v18, v19
    v_cvt_pk_bf16_f32 v90, v20, v21
    v_cvt_pk_bf16_f32 v91, v22, v23
    v_cvt_pk_bf16_f32 v92, v24, v25
    v_cvt_pk_bf16_f32 v93, v26, v27
    v_cvt_pk_bf16_f32 v94, v28, v29
    v_cvt_pk_bf16_f32 v95, v30, v31
    s_mul_i32 s21, s21, 180224
    s_add_u32 s21, s21, s29
    s_cmp_lg_u32 s20, 1
    s_cbranch_scc1 L_bv
    s_add_u32 s21, s21, s31
    buffer_store_dwordx4 v[88:91], v132, s[4:7], s21 offen sc1
    buffer_store_dwordx4 v[92:95], v132, s[4:7], s21 offen offset:256 sc1
    s_branch L_bdone
L_bv:
    s_add_u32 s21, s21, s32
    buffer_store_dwordx4 v[88:91], v164, s[4:7], s21 offen sc1
    buffer_store_dwordx4 v[92:95], v164, s[4:7], s21 offen offset:512 sc1
L_bdone:
    v_mov_b32 v160, v162
    s_waitcnt vmcnt(4)
    v_lshlrev_b32 v0, 16, v32
    v_and_b32 v1, 0xffff0000, v32
    v_lshlrev_b32 v2, 16, v33
    v_and_b32 v3, 0xffff0000, v33
    v_lshlrev_b32 v4, 16, v34
    v_and_b32 v5, 0xffff0000, v34
    v_lshlrev_b32 v6, 16, v35
    v_and_b32 v7, 0xffff0000, v35
    v_lshlrev_b32 v8, 16, v32
    v_and_b32 v9, 0xffff0000, v32
    v_lshlrev_b32 v10, 16, v33
    v_and_b32 v11, 0xffff0000, v33
    v_lshlrev_b32 v12, 16, v34
    v_and_b32 v13, 0xffff0000, v34
    v_lshlrev_b32 v14, 16, v35
    v_and_b32 v15, 0xffff0000, v35
    v_lshlrev_b32 v16, 16, v36
    v_and_b32 v17, 0xffff0000, v36
    v_lshlrev_b32 v18, 16, v37
    v_and_b32 v19, 0xffff0000, v37
    v_lshlrev_b32 v20, 16, v38
    v_and_b32 v21, 0xffff0000, v38
    v_lshlrev_b32 v22, 16, v39
    v_and_b32 v23, 0xffff0000, v39
    v_lshlrev_b32 v24, 16, v36
    v_and_b32 v25, 0xffff0000, v36
    v_lshlrev_b32 v26, 16, v37
    v_and_b32 v27, 0xffff0000, v37
    v_lshlrev_b32 v28, 16, v38
    v_and_b32 v29, 0xffff0000, v38
    v_lshlrev_b32 v30, 16, v39
    v_and_b32 v31, 0xffff0000, v39
    v_add_u32 v153, s18, v159
    v_add_u32 v157, s18, v160
    v_xor_b32 v154, 64, v153
    v_xor_b32 v128, 32, v157
    s_mov_b32 s43, s18
    s_add_u32 s18, s18, 32768
    s_cmp_eq_u32 s18, 163840
    s_cselect_b32 s18, 0, s18
    s_mov_b32 s19, 1
    s_barrier
    ds_read_b128 v[32:35], v153 offset:0
    ds_read_b64_tr_b16 v[36:37], v157 offset:0
    ds_read_b64_tr_b16 v[38:39], v157 offset:768
    ds_read_b64_tr_b16 v[40:41], v157 offset:64
    ds_read_b64_tr_b16 v[42:43], v157 offset:832
    ds_read_b128 v[44:47], v153 offset:2048
    ds_read_b64_tr_b16 v[48:49], v128 offset:0
    ds_read_b64_tr_b16 v[50:51], v128 offset:768
    ds_read_b64_tr_b16 v[52:53], v128 offset:64
    ds_read_b64_tr_b16 v[54:55], v128 offset:832
    ds_read_b128 v[56:59], v154 offset:0
    ds_read_b64_tr_b16 v[60:61], v157 offset:6144
    ds_read_b64_tr_b16 v[62:63], v157 offset:6912
    ds_read_b64_tr_b16 v[64:65], v157 offset:6208
    ds_read_b64_tr_b16 v[66:67], v157 offset:6976
    ds_read_b128 v[68:71], v154 offset:2048
    ds_read_b64_tr_b16 v[72:73], v128 offset:6144
    ds_read_b64_tr_b16 v[74:75], v128 offset:6912
    ds_read_b64_tr_b16 v[76:77], v128 offset:6208
    ds_read_b64_tr_b16 v[78:79], v128 offset:6976
    v_add_u32 v153, s18, v159
    v_add_u32 v157, s18, v160
    v_xor_b32 v154, 64, v153
    v_xor_b32 v128, 32, v157
    s_mov_b32 s43, s18
    s_add_u32 s18, s18, 32768
    s_cmp_eq_u32 s18, 163840
    s_cselect_b32 s18, 0, s18
    s_add_u32 s19, s19, 1
    s_waitcnt lgkmcnt(0)
    s_barrier
L_p2lo:
    v_mfma_f32_16x16x32_bf16 v[0:3], v[36:39], v[32:35], v[0:3]
    v_mfma_f32_16x16x32_bf16 v[8:11], v[36:39], v[44:47], v[8:11]
    ds_read_b128 v[80:83], v153 offset:0
    ds_read_b64_tr_b16 v[84:85], v157 offset:0
    ds_read_b64_tr_b16 v[86:87], v157 offset:768
    v_mfma_f32_16x16x32_bf16 v[16:19], v[40:43], v[32:35], v[16:19]
    v_mfma_f32_16x16x32_bf16 v[24:27], v[40:43], v[44:47], v[24:27]
    ds_read_b64_tr_b16 v[88:89], v157 offset:64
    ds_read_b64_tr_b16 v[90:91], v157 offset:832
    ds_read_b128 v[92:95], v153 offset:2048
    v_mfma_f32_16x16x32_bf16 v[4:7], v[48:51], v[32:35], v[4:7]
    v_mfma_f32_16x16x32_bf16 v[12:15], v[48:51], v[44:47], v[12:15]
    ds_read_b64_tr_b16 v[96:97], v128 offset:0
    ds_read_b64_tr_b16 v[98:99], v128 offset:768
    ds_read_b64_tr_b16 v[100:101], v128 offset:64
    v_mfma_f32_16x16x32_bf16 v[20:23], v[52:55], v[32:35], v[20:23]
    v_mfma_f32_16x16x32_bf16 v[28:31], v[52:55], v[44:47], v[28:31]
    ds_read_b64_tr_b16 v[102:103], v128 offset:832
    ds_read_b128 v[104:107], v154 offset:0
    ds_read_b64_tr_b16 v[108:109], v157 offset:6144
    v_mfma_f32_16x16x32_bf16 v[0:3], v[60:63], v[56:59], v[0:3]
    v_mfma_f32_16x16x32_bf16 v[8:11], v[60:63], v[68:71], v[8:11]
    ds_read_b64_tr_b16 v[110:111], v157 offset:6912
    ds_read_b64_tr_b16 v[112:113], v157 offset:6208
    ds_read_b64_tr_b16 v[114:115], v157 offset:6976
    v_mfma_f32_16x16x32_bf16 v[16:19], v[64:67], v[56:59], v[16:19]
    v_mfma_f32_16x16x32_bf16 v[24:27], v[64:67], v[68:71], v[24:27]
    ds_read_b128 v[116:119], v154 offset:2048
    ds_read_b64_tr_b16 v[120:121], v128 offset:6144
    ds_read_b64_tr_b16 v[122:123], v128 offset:6912
    v_mfma_f32_16x16x32_bf16 v[4:7], v[72:75], v[56:59], v[4:7]
    v_mfma_f32_16x16x32_bf16 v[12:15], v[72:75], v[68:71], v[12:15]
    ds_read_b64_tr_b16 v[124:125], v128 offset:6208
    ds_read_b64_tr_b16 v[126:127], v128 offset:6976
    v_add_u32 v153, s18, v159
    v_add_u32 v157, s18, v160
    v_xor_b32 v154, 64, v153
    v_xor_b32 v128, 32, v157
    s_mov_b32 s43, s18
    s_add_u32 s18, s18, 32768
    s_cmp_eq_u32 s18, 163840
    s_cselect_b32 s18, 0, s18
    v_mfma_f32_16x16x32_bf16 v[20:23], v[76:79], v[56:59], v[20:23]
    v_mfma_f32_16x16x32_bf16 v[28:31], v[76:79], v[68:71], v[28:31]
    s_cmp_eq_u32 s19, 10
    s_cbranch_scc1 L_p2lo_last
    s_add_u32 s19, s19, 1
    s_waitcnt lgkmcnt(0)
    s_barrier
    v_mfma_f32_16x16x32_bf16 v[0:3], v[84:87], v[80:83], v[0:3]
    v_mfma_f32_16x16x32_bf16 v[8:11], v[84:87], v[92:95], v[8:11]
    ds_read_b128 v[32:35], v153 offset:0
    ds_read_b64_tr_b16 v[36:37], v157 offset:0
    ds_read_b64_tr_b16 v[38:39], v157 offset:768
    v_mfma_f32_16x16x32_bf16 v[16:19], v[88:91], v[80:83], v[16:19]
    v_mfma_f32_16x16x32_bf16 v[24:27], v[88:91], v[92:95], v[24:27]
    ds_read_b64_tr_b16 v[40:41], v157 offset:64
    ds_read_b64_tr_b16 v[42:43], v157 offset:832
    ds_read_b128 v[44:47], v153 offset:2048
    v_mfma_f32_16x16x32_bf16 v[4:7], v[96:99], v[80:83], v[4:7]
    v_mfma_f32_16x16x32_bf16 v[12:15], v[96:99], v[92:95], v[12:15]
    ds_read_b64_tr_b16 v[48:49], v128 offset:0
    ds_read_b64_tr_b16 v[50:51], v128 offset:768
    ds_read_b64_tr_b16 v[52:53], v128 offset:64
    v_mfma_f32_16x16x32_bf16 v[20:23], v[100:103], v[80:83], v[20:23]
    v_mfma_f32_16x16x32_bf16 v[28:31], v[100:103], v[92:95], v[28:31]
    ds_read_b64_tr_b16 v[54:55], v128 offset:832
    ds_read_b128 v[56:59], v154 offset:0
    ds_read_b64_tr_b16 v[60:61], v157 offset:6144
    v_mfma_f32_16x16x32_bf16 v[0:3], v[108:111], v[104:107], v[0:3]
    v_mfma_f32_16x16x32_bf16 v[8:11], v[108:111], v[116:119], v[8:11]
    ds_read_b64_tr_b16 v[62:63], v157 offset:6912
    ds_read_b64_tr_b16 v[64:65], v157 offset:6208
    ds_read_b64_tr_b16 v[66:67], v157 offset:6976
    v_mfma_f32_16x16x32_bf16 v[16:19], v[112:115], v[104:107], v[16:19]
    v_mfma_f32_16x16x32_bf16 v[24:27], v[112:115], v[116:119], v[24:27]
    ds_read_b128 v[68:71], v154 offset:2048
    ds_read_b64_tr_b16 v[72:73], v128 offset:6144
    ds_read_b64_tr_b16 v[74:75], v128 offset:6912
    v_mfma_f32_16x16x32_bf16 v[4:7], v[120:123], v[104:107], v[4:7]
    v_mfma_f32_16x16x32_bf16 v[12:15], v[120:123], v[116:119], v[12:15]
    ds_read_b64_tr_b16 v[76:77], v128 offset:6208
    ds_read_b64_tr_b16 v[78:79], v128 offset:6976
    v_add_u32 v153, s18, v159
    v_add_u32 v157, s18, v160
    v_xor_b32 v154, 64, v153
    v_xor_b32 v128, 32, v157
    s_mov_b32 s43, s18
    s_add_u32 s18, s18, 32768
    s_cmp_eq_u32 s18, 163840
    s_cselect_b32 s18, 0, s18
    v_mfma_f32_16x16x32_bf16 v[20:23], v[124:127], v[104:107], v[20:23]
    v_mfma_f32_16x16x32_bf16 v[28:31], v[124:127], v[116:119], v[28:31]
    s_cmp_lg_u32 s19, 3
    s_cbranch_scc1 L_p2lo_h3
    s_waitcnt vmcnt(0)
L_p2lo_h3:
    s_add_u32 s19, s19, 1
    s_waitcnt lgkmcnt(0)
    s_barrier
    s_branch L_p2lo
L_p2lo_last:
    s_mov_b32 s18, s43
    s_waitcnt lgkmcnt(0)
    v_mfma_f32_16x16x32_bf16 v[0:3], v[84:87], v[80:83], v[0:3]
    v_mfma_f32_16x16x32_bf16 v[8:11], v[84:87], v[92:95], v[8:11]
    v_mfma_f32_16x16x32_bf16 v[16:19], v[88:91], v[80:83], v[16:19]
    v_mfma_f32_16x16x32_bf16 v[24:27], v[88:91], v[92:95], v[24:27]
    v_mfma_f32_16x16x32_bf16 v[4:7], v[96:99], v[80:83], v[4:7]
    v_mfma_f32_16x16x32_bf16 v[12:15], v[96:99], v[92:95], v[12:15]
    v_mfma_f32_16x16x32_bf16 v[20:23], v[100:103], v[80:83], v[20:23]
    v_mfma_f32_16x16x32_bf16 v[28:31], v[100:103], v[92:95], v[28:31]
    v_mfma_f32_16x16x32_bf16 v[0:3], v[108:111], v[104:107], v[0:3]
    v_mfma_f32_16x16x32_bf16 v[8:11], v[108:111], v[116:119], v[8:11]
    v_mfma_f32_16x16x32_bf16 v[16:19], v[112:115], v[104:107], v[16:19]
    v_mfma_f32_16x16x32_bf16 v[24:27], v[112:115], v[116:119], v[24:27]
    v_mfma_f32_16x16x32_bf16 v[4:7], v[120:123], v[104:107], v[4:7]
    v_mfma_f32_16x16x32_bf16 v[12:15], v[120:123], v[116:119], v[12:15]
    v_mfma_f32_16x16x32_bf16 v[20:23], v[124:127], v[104:107], v[20:23]
    v_mfma_f32_16x16x32_bf16 v[28:31], v[124:127], v[116:119], v[28:31]
    s_mul_i32 s21, s23, 98304
    s_mul_i32 s22, s13, 6144
    s_add_u32 s21, s21, s22
    s_add_u32 s21, s21, 11010048
    s_waitcnt vmcnt(0)
    s_nop 6
    v_pk_mul_f32 v[88:89], v[0:1], s[44:45]
    v_pk_mul_f32 v[90:91], v[2:3], s[44:45]
    v_pk_mul_f32 v[92:93], v[4:5], s[44:45]
    v_pk_mul_f32 v[94:95], v[6:7], s[44:45]
    v_min_f32 v88, s35, v88
    v_min_f32 v89, s35, v89
    v_min_f32 v90, s35, v90
    v_min_f32 v91, s35, v91
    v_min_f32 v92, s35, v92
    v_min_f32 v93, s35, v93
    v_min_f32 v94, s35, v94
    v_min_f32 v95, s35, v95
    v_exp_f32 v88, v88
    v_exp_f32 v89, v89
    v_exp_f32 v90, v90
    v_exp_f32 v91, v91
    v_exp_f32 v92, v92
    v_exp_f32 v93, v93
    v_exp_f32 v94, v94
    v_exp_f32 v95, v95
    v_pk_add_f32 v[96:97], v[88:89], s[46:47]
    v_pk_add_f32 v[98:99], v[90:91], s[46:47]
    v_pk_add_f32 v[100:101], v[92:93], s[46:47]
    v_pk_add_f32 v[102:103], v[94:95], s[46:47]
    v_pk_mul_f32 v[88:89], v[88:89], v[96:97]
    v_pk_mul_f32 v[90:91], v[90:91], v[98:99]
    v_pk_mul_f32 v[92:93], v[92:93], v[100:101]
    v_pk_mul_f32 v[94:95], v[94:95], v[102:103]
    v_pk_add_f32 v[96:97], v[88:89], s[46:47]
    v_pk_add_f32 v[98:99], v[90:91], s[46:47]
    v_pk_add_f32 v[100:101], v[92:93], s[46:47]
    v_pk_add_f32 v[102:103], v[94:95], s[46:47]
    v_rcp_f32 v96, v96
    v_rcp_f32 v97, v97
    v_rcp_f32 v98, v98
    v_rcp_f32 v99, v99
    v_rcp_f32 v100, v100
    v_rcp_f32 v101, v101
    v_rcp_f32 v102, v102
    v_rcp_f32 v103, v103
    v_pk_mul_f32 v[88:89], v[88:89], v[0:1]
    v_pk_mul_f32 v[90:91], v[90:91], v[2:3]
    v_pk_mul_f32 v[92:93], v[92:93], v[4:5]
    v_pk_mul_f32 v[94:95], v[94:95], v[6:7]
    v_pk_mul_f32 v[88:89], v[88:89], v[96:97]
    v_pk_mul_f32 v[90:91], v[90:91], v[98:99]
    v_pk_mul_f32 v[92:93], v[92:93], v[100:101]
    v_pk_mul_f32 v[94:95], v[94:95], v[102:103]
    v_cvt_pk_bf16_f32 v104, v88, v89
    v_cvt_pk_bf16_f32 v105, v90, v91
    v_cvt_pk_bf16_f32 v106, v92, v93
    v_cvt_pk_bf16_f32 v107, v94, v95
    v_pk_mul_f32 v[88:89], v[8:9], s[44:45]
    v_pk_mul_f32 v[90:91], v[10:11], s[44:45]
    v_pk_mul_f32 v[92:93], v[12:13], s[44:45]
    v_pk_mul_f32 v[94:95], v[14:15], s[44:45]
    v_min_f32 v88, s35, v88
    v_min_f32 v89, s35, v89
    v_min_f32 v90, s35, v90
    v_min_f32 v91, s35, v91
    v_min_f32 v92, s35, v92
    v_min_f32 v93, s35, v93
    v_min_f32 v94, s35, v94
    v_min_f32 v95, s35, v95
    v_exp_f32 v88, v88
    v_exp_f32 v89, v89
    v_exp_f32 v90, v90
    v_exp_f32 v91, v91
    v_exp_f32 v92, v92
    v_exp_f32 v93, v93
    v_exp_f32 v94, v94
    v_exp_f32 v95, v95
    v_pk_add_f32 v[96:97], v[88:89], s[46:47]
    v_pk_add_f32 v[98:99], v[90:91], s[46:47]
    v_pk_add_f32 v[100:101], v[92:93], s[46:47]
    v_pk_add_f32 v[102:103], v[94:95], s[46:47]
    v_pk_mul_f32 v[88:89], v[88:89], v[96:97]
    v_pk_mul_f32 v[90:91], v[90:91], v[98:99]
    v_pk_mul_f32 v[92:93], v[92:93], v[100:101]
    v_pk_mul_f32 v[94:95], v[94:95], v[102:103]
    v_pk_add_f32 v[96:97], v[88:89], s[46:47]
    v_pk_add_f32 v[98:99], v[90:91], s[46:47]
    v_pk_add_f32 v[100:101], v[92:93], s[46:47]
    v_pk_add_f32 v[102:103], v[94:95], s[46:47]
    v_rcp_f32 v96, v96
    v_rcp_f32 v97, v97
    v_rcp_f32 v98, v98
    v_rcp_f32 v99, v99
    v_rcp_f32 v100, v100
    v_rcp_f32 v101, v101
    v_rcp_f32 v102, v102
    v_rcp_f32 v103, v103
    v_pk_mul_f32 v[88:89], v[88:89], v[8:9]
    v_pk_mul_f32 v[90:91], v[90:91], v[10:11]
    v_pk_mul_f32 v[92:93], v[92:93], v[12:13]
    v_pk_mul_f32 v[94:95], v[94:95], v[14:15]
    v_pk_mul_f32 v[88:89], v[88:89], v[96:97]
    v_pk_mul_f32 v[90:91], v[90:91], v[98:99]
    v_pk_mul_f32 v[92:93], v[92:93], v[100:101]
    v_pk_mul_f32 v[94:95], v[94:95], v[102:103]
    v_cvt_pk_bf16_f32 v108, v88, v89
    v_cvt_pk_bf16_f32 v109, v90, v91
    v_cvt_pk_bf16_f32 v110, v92, v93
    v_cvt_pk_bf16_f32 v111, v94, v95
    buffer_store_dwordx4 v[104:107], v167, s[4:7], s21 offen offset:0 sc1
    buffer_store_dwordx4 v[108:111], v167, s[4:7], s21 offen offset:256 sc1
    v_pk_mul_f32 v[88:89], v[16:17], s[44:45]
    v_pk_mul_f32 v[90:91], v[18:19], s[44:45]
    v_pk_mul_f32 v[92:93], v[20:21], s[44:45]
    v_pk_mul_f32 v[94:95], v[22:23], s[44:45]
    v_min_f32 v88, s35, v88
    v_min_f32 v89, s35, v89
    v_min_f32 v90, s35, v90
    v_min_f32 v91, s35, v91
    v_min_f32 v92, s35, v92
    v_min_f32 v93, s35, v93
    v_min_f32 v94, s35, v94
    v_min_f32 v95, s35, v95
    v_exp_f32 v88, v88
    v_exp_f32 v89, v89
    v_exp_f32 v90, v90
    v_exp_f32 v91, v91
    v_exp_f32 v92, v92
    v_exp_f32 v93, v93
    v_exp_f32 v94, v94
    v_exp_f32 v95, v95
    v_pk_add_f32 v[96:97], v[88:89], s[46:47]
    v_pk_add_f32 v[98:99], v[90:91], s[46:47]
    v_pk_add_f32 v[100:101], v[92:93], s[46:47]
    v_pk_add_f32 v[102:103], v[94:95], s[46:47]
    v_pk_mul_f32 v[88:89], v[88:89], v[96:97]
    v_pk_mul_f32 v[90:91], v[90:91], v[98:99]
    v_pk_mul_f32 v[92:93], v[92:93], v[100:101]
    v_pk_mul_f32 v[94:95], v[94:95], v[102:103]
    v_pk_add_f32 v[96:97], v[88:89], s[46:47]
    v_pk_add_f32 v[98:99], v[90:91], s[46:47]
    v_pk_add_f32 v[100:101], v[92:93], s[46:47]
    v_pk_add_f32 v[102:103], v[94:95], s[46:47]
    v_rcp_f32 v96, v96
    v_rcp_f32 v97, v97
    v_rcp_f32 v98, v98
    v_rcp_f32 v99, v99
    v_rcp_f32 v100, v100
    v_rcp_f32 v101, v101
    v_rcp_f32 v102, v102
    v_rcp_f32 v103, v103
    v_pk_mul_f32 v[88:89], v[88:89], v[16:17]
    v_pk_mul_f32 v[90:91], v[90:91], v[18:19]
    v_pk_mul_f32 v[92:93], v[92:93], v[20:21]
    v_pk_mul_f32 v[94:95], v[94:95], v[22:23]
    v_pk_mul_f32 v[88:89], v[88:89], v[96:97]
    v_pk_mul_f32 v[90:91], v[90:91], v[98:99]
    v_pk_mul_f32 v[92:93], v[92:93], v[100:101]
    v_pk_mul_f32 v[94:95], v[94:95], v[102:103]
    v_cvt_pk_bf16_f32 v112, v88, v89
    v_cvt_pk_bf16_f32 v113, v90, v91
    v_cvt_pk_bf16_f32 v114, v92, v93
    v_cvt_pk_bf16_f32 v115, v94, v95
    v_pk_mul_f32 v[88:89], v[24:25], s[44:45]
    v_pk_mul_f32 v[90:91], v[26:27], s[44:45]
    v_pk_mul_f32 v[92:93], v[28:29], s[44:45]
    v_pk_mul_f32 v[94:95], v[30:31], s[44:45]
    v_min_f32 v88, s35, v88
    v_min_f32 v89, s35, v89
    v_min_f32 v90, s35, v90
    v_min_f32 v91, s35, v91
    v_min_f32 v92, s35, v92
    v_min_f32 v93, s35, v93
    v_min_f32 v94, s35, v94
    v_min_f32 v95, s35, v95
    v_exp_f32 v88, v88
    v_exp_f32 v89, v89
    v_exp_f32 v90, v90
    v_exp_f32 v91, v91
    v_exp_f32 v92, v92
    v_exp_f32 v93, v93
    v_exp_f32 v94, v94
    v_exp_f32 v95, v95
    v_pk_add_f32 v[96:97], v[88:89], s[46:47]
    v_pk_add_f32 v[98:99], v[90:91], s[46:47]
    v_pk_add_f32 v[100:101], v[92:93], s[46:47]
    v_pk_add_f32 v[102:103], v[94:95], s[46:47]
    v_pk_mul_f32 v[88:89], v[88:89], v[96:97]
    v_pk_mul_f32 v[90:91], v[90:91], v[98:99]
    v_pk_mul_f32 v[92:93], v[92:93], v[100:101]
    v_pk_mul_f32 v[94:95], v[94:95], v[102:103]
    v_pk_add_f32 v[96:97], v[88:89], s[46:47]
    v_pk_add_f32 v[98:99], v[90:91], s[46:47]
    v_pk_add_f32 v[100:101], v[92:93], s[46:47]
    v_pk_add_f32 v[102:103], v[94:95], s[46:47]
    v_rcp_f32 v96, v96
    v_rcp_f32 v97, v97
    v_rcp_f32 v98, v98
    v_rcp_f32 v99, v99
    v_rcp_f32 v100, v100
    v_rcp_f32 v101, v101
    v_rcp_f32 v102, v102
    v_rcp_f32 v103, v103
    v_pk_mul_f32 v[88:89], v[88:89], v[24:25]
    v_pk_mul_f32 v[90:91], v[90:91], v[26:27]
    v_pk_mul_f32 v[92:93], v[92:93], v[28:29]
    v_pk_mul_f32 v[94:95], v[94:95], v[30:31]
    v_pk_mul_f32 v[88:89], v[88:89], v[96:97]
    v_pk_mul_f32 v[90:91], v[90:91], v[98:99]
    v_pk_mul_f32 v[92:93], v[92:93], v[100:101]
    v_pk_mul_f32 v[94:95], v[94:95], v[102:103]
    v_cvt_pk_bf16_f32 v116, v88, v89
    v_cvt_pk_bf16_f32 v117, v90, v91
    v_cvt_pk_bf16_f32 v118, v92, v93
    v_cvt_pk_bf16_f32 v119, v94, v95
    buffer_store_dwordx4 v[112:115], v167, s[4:7], s21 offen offset:2048 sc1
    buffer_store_dwordx4 v[116:119], v167, s[4:7], s21 offen offset:2304 sc1
    s_branch L_attn
L_hi:
    s_setprio 0
    v_add_u32 v153, s18, v159
    v_add_u32 v157, s18, v160
    v_add_u32 v158, s18, v161
    v_xor_b32 v154, 64, v153
    v_xor_b32 v128, 32, v157
    v_xor_b32 v129, 32, v158
    s_mov_b32 s43, s18
    s_add_u32 s18, s18, 32768
    s_cmp_eq_u32 s18, 163840
    s_cselect_b32 s18, 0, s18
    s_mov_b32 s19, 1
    s_barrier
    ds_read_b128 v[32:35], v153 offset:0
    ds_read_b64_tr_b16 v[36:37], v157 offset:0
    ds_read_b64_tr_b16 v[38:39], v157 offset:1024
    ds_read_b64_tr_b16 v[40:41], v158 offset:0
    ds_read_b64_tr_b16 v[42:43], v158 offset:1024
    ds_read_b128 v[44:47], v153 offset:2048
    ds_read_b64_tr_b16 v[48:49], v128 offset:0
    ds_read_b64_tr_b16 v[50:51], v128 offset:1024
    ds_read_b64_tr_b16 v[52:53], v129 offset:0
    ds_read_b64_tr_b16 v[54:55], v129 offset:1024
    ds_read_b128 v[56:59], v154 offset:0
    ds_read_b64_tr_b16 v[60:61], v157 offset:8192
    ds_read_b64_tr_b16 v[62:63], v157 offset:9216
    ds_read_b64_tr_b16 v[64:65], v158 offset:8192
    ds_read_b64_tr_b16 v[66:67], v158 offset:9216
    ds_read_b128 v[68:71], v154 offset:2048
    ds_read_b64_tr_b16 v[72:73], v128 offset:8192
    ds_read_b64_tr_b16 v[74:75], v128 offset:9216
    ds_read_b64_tr_b16 v[76:77], v129 offset:8192
    ds_read_b64_tr_b16 v[78:79], v129 offset:9216
    v_add_u32 v153, s18, v159
    v_add_u32 v157, s18, v160
    v_add_u32 v158, s18, v161
    v_xor_b32 v154, 64, v153
    v_xor_b32 v128, 32, v157
    v_xor_b32 v129, 32, v158
    s_mov_b32 s43, s18
    s_add_u32 s18, s18, 32768
    s_cmp_eq_u32 s18, 163840
    s_cselect_b32 s18, 0, s18
    s_add_u32 s19, s19, 1
    s_waitcnt lgkmcnt(0)
    s_barrier
L_p1hi:
    v_mfma_f32_16x16x32_bf16 v[0:3], v[36:39], v[32:35], v[0:3]
    v_mfma_f32_16x16x32_bf16 v[8:11], v[36:39], v[44:47], v[8:11]
    ds_read_b128 v[80:83], v153 offset:0
    ds_read_b64_tr_b16 v[84:85], v157 offset:0
    ds_read_b64_tr_b16 v[86:87], v157 offset:1024
    v_mfma_f32_16x16x32_bf16 v[16:19], v[40:43], v[32:35], v[16:19]
    v_mfma_f32_16x16x32_bf16 v[24:27], v[40:43], v[44:47], v[24:27]
    ds_read_b64_tr_b16 v[88:89], v158 offset:0
    ds_read_b64_tr_b16 v[90:91], v158 offset:1024
    ds_read_b128 v[92:95], v153 offset:2048
    v_mfma_f32_16x16x32_bf16 v[4:7], v[48:51], v[32:35], v[4:7]
    v_mfma_f32_16x16x32_bf16 v[12:15], v[48:51], v[44:47], v[12:15]
    ds_read_b64_tr_b16 v[96:97], v128 offset:0
    ds_read_b64_tr_b16 v[98:99], v128 offset:1024
    ds_read_b64_tr_b16 v[100:101], v129 offset:0
    v_mfma_f32_16x16x32_bf16 v[20:23], v[52:55], v[32:35], v[20:23]
    v_mfma_f32_16x16x32_bf16 v[28:31], v[52:55], v[44:47], v[28:31]
    ds_read_b64_tr_b16 v[102:103], v129 offset:1024
    ds_read_b128 v[104:107], v154 offset:0
    ds_read_b64_tr_b16 v[108:109], v157 offset:8192
    v_mfma_f32_16x16x32_bf16 v[0:3], v[60:63], v[56:59], v[0:3]
    v_mfma_f32_16x16x32_bf16 v[8:11], v[60:63], v[68:71], v[8:11]
    ds_read_b64_tr_b16 v[110:111], v157 offset:9216
    ds_read_b64_tr_b16 v[112:113], v158 offset:8192
    ds_read_b64_tr_b16 v[114:115], v158 offset:9216
    v_mfma_f32_16x16x32_bf16 v[16:19], v[64:67], v[56:59], v[16:19]
    v_mfma_f32_16x16x32_bf16 v[24:27], v[64:67], v[68:71], v[24:27]
    ds_read_b128 v[116:119], v154 offset:2048
    ds_read_b64_tr_b16 v[120:121], v128 offset:8192
    ds_read_b64_tr_b16 v[122:123], v128 offset:9216
    v_mfma_f32_16x16x32_bf16 v[4:7], v[72:75], v[56:59], v[4:7]
    v_mfma_f32_16x16x32_bf16 v[12:15], v[72:75], v[68:71], v[12:15]
    ds_read_b64_tr_b16 v[124:125], v129 offset:8192
    ds_read_b64_tr_b16 v[126:127], v129 offset:9216
    v_add_u32 v153, s18, v159
    v_add_u32 v157, s18, v160
    v_add_u32 v158, s18, v161
    v_xor_b32 v154, 64, v153
    v_xor_b32 v128, 32, v157
    v_xor_b32 v129, 32, v158
    s_mov_b32 s43, s18
    s_add_u32 s18, s18, 32768
    s_cmp_eq_u32 s18, 163840
    s_cselect_b32 s18, 0, s18
    v_mfma_f32_16x16x32_bf16 v[20:23], v[76:79], v[56:59], v[20:23]
    v_mfma_f32_16x16x32_bf16 v[28:31], v[76:79], v[68:71], v[28:31]
    s_cmp_eq_u32 s19, 10
    s_cbranch_scc1 L_p1hi_last
    s_add_u32 s19, s19, 1
    s_waitcnt lgkmcnt(0)
    s_barrier
    v_mfma_f32_16x16x32_bf16 v[0:3], v[84:87], v[80:83], v[0:3]
    v_mfma_f32_16x16x32_bf16 v[8:11], v[84:87], v[92:95], v[8:11]
    ds_read_b128 v[32:35], v153 offset:0
    ds_read_b64_tr_b16 v[36:37], v157 offset:0
    ds_read_b64_tr_b16 v[38:39], v157 offset:1024
    v_mfma_f32_16x16x32_bf16 v[16:19], v[88:91], v[80:83], v[16:19]
    v_mfma_f32_16x16x32_bf16 v[24:27], v[88:91], v[92:95], v[24:27]
    ds_read_b64_tr_b16 v[40:41], v158 offset:0
    ds_read_b64_tr_b16 v[42:43], v158 offset:1024
    ds_read_b128 v[44:47], v153 offset:2048
    v_mfma_f32_16x16x32_bf16 v[4:7], v[96:99], v[80:83], v[4:7]
    v_mfma_f32_16x16x32_bf16 v[12:15], v[96:99], v[92:95], v[12:15]
    ds_read_b64_tr_b16 v[48:49], v128 offset:0
    ds_read_b64_tr_b16 v[50:51], v128 offset:1024
    ds_read_b64_tr_b16 v[52:53], v129 offset:0
    v_mfma_f32_16x16x32_bf16 v[20:23], v[100:103], v[80:83], v[20:23]
    v_mfma_f32_16x16x32_bf16 v[28:31], v[100:103], v[92:95], v[28:31]
    ds_read_b64_tr_b16 v[54:55], v129 offset:1024
    ds_read_b128 v[56:59], v154 offset:0
    ds_read_b64_tr_b16 v[60:61], v157 offset:8192
    v_mfma_f32_16x16x32_bf16 v[0:3], v[108:111], v[104:107], v[0:3]
    v_mfma_f32_16x16x32_bf16 v[8:11], v[108:111], v[116:119], v[8:11]
    ds_read_b64_tr_b16 v[62:63], v157 offset:9216
    ds_read_b64_tr_b16 v[64:65], v158 offset:8192
    ds_read_b64_tr_b16 v[66:67], v158 offset:9216
    v_mfma_f32_16x16x32_bf16 v[16:19], v[112:115], v[104:107], v[16:19]
    v_mfma_f32_16x16x32_bf16 v[24:27], v[112:115], v[116:119], v[24:27]
    ds_read_b128 v[68:71], v154 offset:2048
    ds_read_b64_tr_b16 v[72:73], v128 offset:8192
    ds_read_b64_tr_b16 v[74:75], v128 offset:9216
    v_mfma_f32_16x16x32_bf16 v[4:7], v[120:123], v[104:107], v[4:7]
    v_mfma_f32_16x16x32_bf16 v[12:15], v[120:123], v[116:119], v[12:15]
    ds_read_b64_tr_b16 v[76:77], v129 offset:8192
    ds_read_b64_tr_b16 v[78:79], v129 offset:9216
    v_add_u32 v153, s18, v159
    v_add_u32 v157, s18, v160
    v_add_u32 v158, s18, v161
    v_xor_b32 v154, 64, v153
    v_xor_b32 v128, 32, v157
    v_xor_b32 v129, 32, v158
    s_mov_b32 s43, s18
    s_add_u32 s18, s18, 32768
    s_cmp_eq_u32 s18, 163840
    s_cselect_b32 s18, 0, s18
    v_mfma_f32_16x16x32_bf16 v[20:23], v[124:127], v[104:107], v[20:23]
    v_mfma_f32_16x16x32_bf16 v[28:31], v[124:127], v[116:119], v[28:31]
    s_add_u32 s19, s19, 1
    s_waitcnt lgkmcnt(0)
    s_barrier
    s_branch L_p1hi
L_p1hi_last:
    s_mov_b32 s18, s43
    s_waitcnt lgkmcnt(0)
    buffer_load_dwordx2 v[32:33], v133, s[8:11], s36 offen offset:0
    buffer_load_dwordx2 v[34:35], v133, s[8:11], s36 offen offset:32
    buffer_load_dwordx2 v[36:37], v133, s[8:11], s36 offen offset:64
    buffer_load_dwordx2 v[38:39], v133, s[8:11], s36 offen offset:96
    v_mfma_f32_16x16x32_bf16 v[0:3], v[84:87], v[80:83], v[0:3]
    v_mfma_f32_16x16x32_bf16 v[8:11], v[84:87], v[92:95], v[8:11]
    v_mfma_f32_16x16x32_bf16 v[16:19], v[88:91], v[80:83], v[16:19]
    v_mfma_f32_16x16x32_bf16 v[24:27], v[88:91], v[92:95], v[24:27]
    v_mfma_f32_16x16x32_bf16 v[4:7], v[96:99], v[80:83], v[4:7]
    v_mfma_f32_16x16x32_bf16 v[12:15], v[96:99], v[92:95], v[12:15]
    v_mfma_f32_16x16x32_bf16 v[20:23], v[100:103], v[80:83], v[20:23]
    v_mfma_f32_16x16x32_bf16 v[28:31], v[100:103], v[92:95], v[28:31]
    v_mfma_f32_16x16x32_bf16 v[0:3], v[108:111], v[104:107], v[0:3]
    v_mfma_f32_16x16x32_bf16 v[8:11], v[108:111], v[116:119], v[8:11]
    v_mfma_f32_16x16x32_bf16 v[16:19], v[112:115], v[104:107], v[16:19]
    v_mfma_f32_16x16x32_bf16 v[24:27], v[112:115], v[116:119], v[24:27]
    v_mfma_f32_16x16x32_bf16 v[4:7], v[120:123], v[104:107], v[4:7]
    v_mfma_f32_16x16x32_bf16 v[12:15], v[120:123], v[116:119], v[12:15]
    v_mfma_f32_16x16x32_bf16 v[20:23], v[124:127], v[104:107], v[20:23]
    v_mfma_f32_16x16x32_bf16 v[28:31], v[124:127], v[116:119], v[28:31]
    s_nop 7
    s_mul_i32 s20, s13, 3
    s_add_u32 s20, s20, 2
    s_and_b32 s21, s20, 15
    s_lshr_b32 s20, s20, 4
    s_lshl_b32 s21, s21, 1
    s_cmp_lg_u32 s20, 0
    s_cbranch_scc1 L_ckv
    v_mul_f32 v0, s30, v0
    v_mul_f32 v1, s30, v1
    v_mul_f32 v2, s30, v2
    v_mul_f32 v3, s30, v3
    v_mul_f32 v4, s30, v4
    v_mul_f32 v5, s30, v5
    v_mul_f32 v6, s30, v6
    v_mul_f32 v7, s30, v7
    v_mul_f32 v8, s30, v8
    v_mul_f32 v9, s30, v9
    v_mul_f32 v10, s30, v10
    v_mul_f32 v11, s30, v11
    v_mul_f32 v12, s30, v12
    v_mul_f32 v13, s30, v13
    v_mul_f32 v14, s30, v14
    v_mul_f32 v15, s30, v15
    v_cvt_pk_bf16_f32 v80, v0, v1
    v_cvt_pk_bf16_f32 v81, v2, v3
    v_cvt_pk_bf16_f32 v82, v4, v5
    v_cvt_pk_bf16_f32 v83, v6, v7
    v_cvt_pk_bf16_f32 v84, v8, v9
    v_cvt_pk_bf16_f32 v85, v10, v11
    v_cvt_pk_bf16_f32 v86, v12, v13
    v_cvt_pk_bf16_f32 v87, v14, v15
    s_lshl_b32 s21, s21, 16
    s_add_u32 s21, s21, s28
    buffer_store_dwordx4 v[80:83], v131, s[4:7], s21 offen sc1
    buffer_store_dwordx4 v[84:87], v131, s[4:7], s21 offen offset:256 sc1
    s_branch L_cdone
L_ckv:
    v_cvt_pk_bf16_f32 v80, v0, v1
    v_cvt_pk_bf16_f32 v81, v2, v3
    v_cvt_pk_bf16_f32 v82, v4, v5
    v_cvt_pk_bf16_f32 v83, v6, v7
    v_cvt_pk_bf16_f32 v84, v8, v9
    v_cvt_pk_bf16_f32 v85, v10, v11
    v_cvt_pk_bf16_f32 v86, v12, v13
    v_cvt_pk_bf16_f32 v87, v14, v15
    s_mul_i32 s21, s21, 180224
    s_add_u32 s21, s21, s29
    s_cmp_lg_u32 s20, 1
    s_cbranch_scc1 L_cv
    s_add_u32 s21, s21, s31
    buffer_store_dwordx4 v[80:83], v132, s[4:7], s21 offen sc1
    buffer_store_dwordx4 v[84:87], v132, s[4:7], s21 offen offset:256 sc1
    s_branch L_cdone
L_cv:
    s_add_u32 s21, s21, s32
    buffer_store_dwordx4 v[80:83], v164, s[4:7], s21 offen sc1
    buffer_store_dwordx4 v[84:87], v164, s[4:7], s21 offen offset:512 sc1
L_cdone:
    v_lshrrev_b32 v100, 4, v163
    v_and_b32 v96, 15, v100
    v_bfe_u32 v100, v100, 4, 1
    v_lshlrev_b32 v99, 4, v96
    v_lshlrev_b32 v96, 3, v96
    v_lshl_add_u32 v97, v100, 14, v96
    v_mul_u32_u24 v100, 180224, v100
    v_add_u32 v98, v100, v96
    v_add_u32 v99, v99, v100
    v_mov_b32 v90, 0x3f80
    v_mov_b32 v91, 0
    v_mov_b32 v94, 0x3f80
    v_mov_b32 v95, 0
    s_mul_i32 s20, s13, 3
    s_add_u32 s20, s20, 0
    s_and_b32 s21, s20, 15
    s_lshr_b32 s20, s20, 4
    s_lshl_b32 s21, s21, 1
    s_mov_b32 exec_hi, 0
    s_cmp_lg_u32 s20, 0
    s_cbranch_scc1 L_tt0kv
    v_mul_f32 v16, s30, v16
    v_mul_f32 v17, s30, v17
    v_mul_f32 v18, s30, v18
    v_mul_f32 v19, s30, v19
    v_cvt_pk_bf16_f32 v88, v16, v17
    v_cvt_pk_bf16_f32 v89, v18, v19
    v_mul_f32 v24, s30, v24
    v_mul_f32 v25, s30, v25
    v_mul_f32 v26, s30, v26
    v_mul_f32 v27, s30, v27
    v_cvt_pk_bf16_f32 v92, v24, v25
    v_cvt_pk_bf16_f32 v93, v26, v27
    s_lshl_b32 s21, s21, 14
    s_add_u32 s21, s21, s33
    buffer_store_dwordx2 v[88:89], v97, s[4:7], s21 offen offset:0 sc1
    buffer_store_dwordx2 v[92:93], v97, s[4:7], s21 offen offset:128 sc1
    s_branch L_tt0done
L_tt0kv:
    v_cvt_pk_bf16_f32 v88, v16, v17
    v_cvt_pk_bf16_f32 v89, v18, v19
    v_cvt_pk_bf16_f32 v92, v24, v25
    v_cvt_pk_bf16_f32 v93, v26, v27
    s_mul_i32 s21, s21, 180224
    s_add_u32 s21, s21, s29
    s_cmp_lg_u32 s20, 1
    s_cbranch_scc1 L_tt0v
    s_add_u32 s21, s21, s34
    buffer_store_dwordx2 v[88:89], v98, s[4:7], s21 offen offset:0 sc1
    buffer_store_dwordx2 v[92:93], v98, s[4:7], s21 offen offset:128 sc1
    s_branch L_tt0done
L_tt0v:
    s_add_u32 s21, s21, s42
    buffer_store_dwordx4 v[88:91], v99, s[4:7], s21 offen offset:0 sc1
    buffer_store_dwordx4 v[92:95], v99, s[4:7], s21 offen offset:256 sc1
L_tt0done:
    s_mov_b64 exec, -1
    s_nop 0
    s_mul_i32 s20, s13, 3
    s_add_u32 s20, s20, 1
    s_and_b32 s21, s20, 15
    s_lshr_b32 s20, s20, 4
    s_lshl_b32 s21, s21, 1
    s_mov_b32 exec_lo, 0
    s_cmp_lg_u32 s20, 0
    s_cbranch_scc1 L_tt1kv
    v_mul_f32 v16, s30, v16
    v_mul_f32 v17, s30, v17
    v_mul_f32 v18, s30, v18
    v_mul_f32 v19, s30, v19
    v_cvt_pk_bf16_f32 v88, v16, v17
    v_cvt_pk_bf16_f32 v89, v18, v19
    v_mul_f32 v24, s30, v24
    v_mul_f32 v25, s30, v25
    v_mul_f32 v26, s30, v26
    v_mul_f32 v27, s30, v27
    v_cvt_pk_bf16_f32 v92, v24, v25
    v_cvt_pk_bf16_f32 v93, v26, v27
    s_lshl_b32 s21, s21, 14
    s_add_u32 s21, s21, s33
    buffer_store_dwordx2 v[88:89], v97, s[4:7], s21 offen offset:0 sc1
    buffer_store_dwordx2 v[92:93], v97, s[4:7], s21 offen offset:128 sc1
    s_branch L_tt1done
L_tt1kv:
    v_cvt_pk_bf16_f32 v88, v16, v17
    v_cvt_pk_bf16_f32 v89, v18, v19
    v_cvt_pk_bf16_f32 v92, v24, v25
    v_cvt_pk_bf16_f32 v93, v26, v27
    s_mul_i32 s21, s21, 180224
    s_add_u32 s21, s21, s29
    s_cmp_lg_u32 s20, 1
    s_cbranch_scc1 L_tt1v
    s_add_u32 s21, s21, s34
    buffer_store_dwordx2 v[88:89], v98, s[4:7], s21 offen offset:0 sc1
    buffer_store_dwordx2 v[92:93], v98, s[4:7], s21 offen offset:128 sc1
    s_branch L_tt1done
L_tt1v:
    s_add_u32 s21, s21, s42
    buffer_store_dwordx4 v[88:91], v99, s[4:7], s21 offen offset:0 sc1
    buffer_store_dwordx4 v[92:95], v99, s[4:7], s21 offen offset:256 sc1
L_tt1done:
    s_mov_b64 exec, -1
    s_nop 0
    s_mul_i32 s20, s13, 3
    s_add_u32 s20, s20, 2
    s_and_b32 s21, s20, 15
    s_lshr_b32 s20, s20, 4
    s_lshl_b32 s21, s21, 1
    s_mov_b32 exec_hi, 0
    s_cmp_lg_u32 s20, 0
    s_cbranch_scc1 L_tt2kv
    v_mul_f32 v20, s30, v20
    v_mul_f32 v21, s30, v21
    v_mul_f32 v22, s30, v22
    v_mul_f32 v23, s30, v23
    v_cvt_pk_bf16_f32 v88, v20, v21
    v_cvt_pk_bf16_f32 v89, v22, v23
    v_mul_f32 v28, s30, v28
    v_mul_f32 v29, s30, v29
    v_mul_f32 v30, s30, v30
    v_mul_f32 v31, s30, v31
    v_cvt_pk_bf16_f32 v92, v28, v29
    v_cvt_pk_bf16_f32 v93, v30, v31
    s_lshl_b32 s21, s21, 14
    s_add_u32 s21, s21, s33
    buffer_store_dwordx2 v[88:89], v97, s[4:7], s21 offen offset:0 sc1
    buffer_store_dwordx2 v[92:93], v97, s[4:7], s21 offen offset:128 sc1
    s_branch L_tt2done
L_tt2kv:
    v_cvt_pk_bf16_f32 v88, v20, v21
    v_cvt_pk_bf16_f32 v89, v22, v23
    v_cvt_pk_bf16_f32 v92, v28, v29
    v_cvt_pk_bf16_f32 v93, v30, v31
    s_mul_i32 s21, s21, 180224
    s_add_u32 s21, s21, s29
    s_cmp_lg_u32 s20, 1
    s_cbranch_scc1 L_tt2v
    s_add_u32 s21, s21, s34
    buffer_store_dwordx2 v[88:89], v98, s[4:7], s21 offen offset:0 sc1
    buffer_store_dwordx2 v[92:93], v98, s[4:7], s21 offen offset:128 sc1
    s_branch L_tt2done
L_tt2v:
    s_add_u32 s21, s21, s42
    buffer_store_dwordx4 v[88:91], v99, s[4:7], s21 offen offset:0 sc1
    buffer_store_dwordx4 v[92:95], v99, s[4:7], s21 offen offset:256 sc1
L_tt2done:
    s_mov_b64 exec, -1
    s_nop 0
    v_mov_b32 v160, v162
    s_waitcnt vmcnt(8)
    v_lshlrev_b32 v0, 16, v32
    v_and_b32 v1, 0xffff0000, v32
    v_lshlrev_b32 v2, 16, v33
    v_and_b32 v3, 0xffff0000, v33
    v_lshlrev_b32 v4, 16, v34
    v_and_b32 v5, 0xffff0000, v34
    v_lshlrev_b32 v6, 16, v35
    v_and_b32 v7, 0xffff0000, v35
    v_lshlrev_b32 v8, 16, v32
    v_and_b32 v9, 0xffff0000, v32
    v_lshlrev_b32 v10, 16, v33
    v_and_b32 v11, 0xffff0000, v33
    v_lshlrev_b32 v12, 16, v34
    v_and_b32 v13, 0xffff0000, v34
    v_lshlrev_b32 v14, 16, v35
    v_and_b32 v15, 0xffff0000, v35
    s_setprio 0
    v_add_u32 v153, s18, v159
    v_add_u32 v157, s18, v160
    v_xor_b32 v154, 64, v153
    v_xor_b32 v128, 32, v157
    s_mov_b32 s43, s18
    s_add_u32 s18, s18, 32768
    s_cmp_eq_u32 s18, 163840
    s_cselect_b32 s18, 0, s18
    s_mov_b32 s19, 1
    s_barrier
    ds_read_b128 v[32:35], v153 offset:0
    ds_read_b64_tr_b16 v[36:37], v157 offset:0
    ds_read_b64_tr_b16 v[38:39], v157 offset:768
    ds_read_b128 v[44:47], v153 offset:2048
    ds_read_b64_tr_b16 v[48:49], v128 offset:0
    ds_read_b64_tr_b16 v[50:51], v128 offset:768
    ds_read_b128 v[56:59], v154 offset:0
    ds_read_b64_tr_b16 v[60:61], v157 offset:6144
    ds_read_b64_tr_b16 v[62:63], v157 offset:6912
    ds_read_b128 v[68:71], v154 offset:2048
    ds_read_b64_tr_b16 v[72:73], v128 offset:6144
    ds_read_b64_tr_b16 v[74:75], v128 offset:6912
    v_add_u32 v153, s18, v159
    v_add_u32 v157, s18, v160
    v_xor_b32 v154, 64, v153
    v_xor_b32 v128, 32, v157
    s_mov_b32 s43, s18
    s_add_u32 s18, s18, 32768
    s_cmp_eq_u32 s18, 163840
    s_cselect_b32 s18, 0, s18
    s_add_u32 s19, s19, 1
    s_waitcnt lgkmcnt(0)
    s_barrier
L_p2hi:
    ds_read_b128 v[80:83], v153 offset:0
    ds_read_b64_tr_b16 v[84:85], v157 offset:0
    ds_read_b64_tr_b16 v[86:87], v157 offset:768
    ds_read_b128 v[92:95], v153 offset:2048
    ds_read_b64_tr_b16 v[96:97], v128 offset:0
    ds_read_b64_tr_b16 v[98:99], v128 offset:768
    ds_read_b128 v[104:107], v154 offset:0
    ds_read_b64_tr_b16 v[108:109], v157 offset:6144
    ds_read_b64_tr_b16 v[110:111], v157 offset:6912
    ds_read_b128 v[116:119], v154 offset:2048
    ds_read_b64_tr_b16 v[120:121], v128 offset:6144
    ds_read_b64_tr_b16 v[122:123], v128 offset:6912
    v_add_u32 v153, s18, v159
    v_add_u32 v157, s18, v160
    v_xor_b32 v154, 64, v153
    v_xor_b32 v128, 32, v157
    s_mov_b32 s43, s18
    s_add_u32 s18, s18, 32768
    s_cmp_eq_u32 s18, 163840
    s_cselect_b32 s18, 0, s18
    v_mfma_f32_16x16x32_bf16 v[0:3], v[36:39], v[32:35], v[0:3]
    v_mfma_f32_16x16x32_bf16 v[8:11], v[36:39], v[44:47], v[8:11]
    v_mfma_f32_16x16x32_bf16 v[4:7], v[48:51], v[32:35], v[4:7]
    v_mfma_f32_16x16x32_bf16 v[12:15], v[48:51], v[44:47], v[12:15]
    v_mfma_f32_16x16x32_bf16 v[0:3], v[60:63], v[56:59], v[0:3]
    v_mfma_f32_16x16x32_bf16 v[8:11], v[60:63], v[68:71], v[8:11]
    v_mfma_f32_16x16x32_bf16 v[4:7], v[72:75], v[56:59], v[4:7]
    v_mfma_f32_16x16x32_bf16 v[12:15], v[72:75], v[68:71], v[12:15]
    s_cmp_eq_u32 s19, 10
    s_cbranch_scc1 L_p2hi_last
    s_add_u32 s19, s19, 1
    s_waitcnt lgkmcnt(0)
    s_barrier
    ds_read_b128 v[32:35], v153 offset:0
    ds_read_b64_tr_b16 v[36:37], v157 offset:0
    ds_read_b64_tr_b16 v[38:39], v157 offset:768
    ds_read_b128 v[44:47], v153 offset:2048
    ds_read_b64_tr_b16 v[48:49], v128 offset:0
    ds_read_b64_tr_b16 v[50:51], v128 offset:768
    ds_read_b128 v[56:59], v154 offset:0
    ds_read_b64_tr_b16 v[60:61], v157 offset:6144
    ds_read_b64_tr_b16 v[62:63], v157 offset:6912
    ds_read_b128 v[68:71], v154 offset:2048
    ds_read_b64_tr_b16 v[72:73], v128 offset:6144
    ds_read_b64_tr_b16 v[74:75], v128 offset:6912
    v_add_u32 v153, s18, v159
    v_add_u32 v157, s18, v160
    v_xor_b32 v154, 64, v153
    v_xor_b32 v128, 32, v157
    s_mov_b32 s43, s18
    s_add_u32 s18, s18, 32768
    s_cmp_eq_u32 s18, 163840
    s_cselect_b32 s18, 0, s18
    v_mfma_f32_16x16x32_bf16 v[0:3], v[84:87], v[80:83], v[0:3]
    v_mfma_f32_16x16x32_bf16 v[8:11], v[84:87], v[92:95], v[8:11]
    v_mfma_f32_16x16x32_bf16 v[4:7], v[96:99], v[80:83], v[4:7]
    v_mfma_f32_16x16x32_bf16 v[12:15], v[96:99], v[92:95], v[12:15]
    v_mfma_f32_16x16x32_bf16 v[0:3], v[108:111], v[104:107], v[0:3]
    v_mfma_f32_16x16x32_bf16 v[8:11], v[108:111], v[116:119], v[8:11]
    v_mfma_f32_16x16x32_bf16 v[4:7], v[120:123], v[104:107], v[4:7]
    v_mfma_f32_16x16x32_bf16 v[12:15], v[120:123], v[116:119], v[12:15]
    s_cmp_lg_u32 s19, 3
    s_cbranch_scc1 L_p2hi_h3
    s_waitcnt vmcnt(0)
L_p2hi_h3:
    s_add_u32 s19, s19, 1
    s_waitcnt lgkmcnt(0)
    s_barrier
    s_branch L_p2hi
L_p2hi_last:
    s_mov_b32 s18, s43
    s_waitcnt lgkmcnt(0)
    v_mfma_f32_16x16x32_bf16 v[0:3], v[84:87], v[80:83], v[0:3]
    v_mfma_f32_16x16x32_bf16 v[8:11], v[84:87], v[92:95], v[8:11]
    v_mfma_f32_16x16x32_bf16 v[4:7], v[96:99], v[80:83], v[4:7]
    v_mfma_f32_16x16x32_bf16 v[12:15], v[96:99], v[92:95], v[12:15]
    v_mfma_f32_16x16x32_bf16 v[0:3], v[108:111], v[104:107], v[0:3]
    v_mfma_f32_16x16x32_bf16 v[8:11], v[108:111], v[116:119], v[8:11]
    v_mfma_f32_16x16x32_bf16 v[4:7], v[120:123], v[104:107], v[4:7]
    v_mfma_f32_16x16x32_bf16 v[12:15], v[120:123], v[116:119], v[12:15]
    s_setprio 0
    s_mul_i32 s21, s23, 98304
    s_mul_i32 s22, s13, 6144
    s_add_u32 s21, s21, s22
    s_add_u32 s21, s21, 11014144
    s_waitcnt vmcnt(0)
    s_nop 6
    v_pk_mul_f32 v[88:89], v[0:1], s[44:45]
    v_pk_mul_f32 v[90:91], v[2:3], s[44:45]
    v_pk_mul_f32 v[92:93], v[4:5], s[44:45]
    v_pk_mul_f32 v[94:95], v[6:7], s[44:45]
    v_min_f32 v88, s35, v88
    v_min_f32 v89, s35, v89
    v_min_f32 v90, s35, v90
    v_min_f32 v91, s35, v91
    v_min_f32 v92, s35, v92
    v_min_f32 v93, s35, v93
    v_min_f32 v94, s35, v94
    v_min_f32 v95, s35, v95
    v_exp_f32 v88, v88
    v_exp_f32 v89, v89
    v_exp_f32 v90, v90
    v_exp_f32 v91, v91
    v_exp_f32 v92, v92
    v_exp_f32 v93, v93
    v_exp_f32 v94, v94
    v_exp_f32 v95, v95
    v_pk_add_f32 v[96:97], v[88:89], s[46:47]
    v_pk_add_f32 v[98:99], v[90:91], s[46:47]
    v_pk_add_f32 v[100:101], v[92:93], s[46:47]
    v_pk_add_f32 v[102:103], v[94:95], s[46:47]
    v_pk_mul_f32 v[88:89], v[88:89], v[96:97]
    v_pk_mul_f32 v[90:91], v[90:91], v[98:99]
    v_pk_mul_f32 v[92:93], v[92:93], v[100:101]
    v_pk_mul_f32 v[94:95], v[94:95], v[102:103]
    v_pk_add_f32 v[96:97], v[88:89], s[46:47]
    v_pk_add_f32 v[98:99], v[90:91], s[46:47]
    v_pk_add_f32 v[100:101], v[92:93], s[46:47]
    v_pk_add_f32 v[102:103], v[94:95], s[46:47]
    v_rcp_f32 v96, v96
    v_rcp_f32 v97, v97
    v_rcp_f32 v98, v98
    v_rcp_f32 v99, v99
    v_rcp_f32 v100, v100
    v_rcp_f32 v101, v101
    v_rcp_f32 v102, v102
    v_rcp_f32 v103, v103
    v_pk_mul_f32 v[88:89], v[88:89], v[0:1]
    v_pk_mul_f32 v[90:91], v[90:91], v[2:3]
    v_pk_mul_f32 v[92:93], v[92:93], v[4:5]
    v_pk_mul_f32 v[94:95], v[94:95], v[6:7]
    v_pk_mul_f32 v[88:89], v[88:89], v[96:97]
    v_pk_mul_f32 v[90:91], v[90:91], v[98:99]
    v_pk_mul_f32 v[92:93], v[92:93], v[100:101]
    v_pk_mul_f32 v[94:95], v[94:95], v[102:103]
    v_cvt_pk_bf16_f32 v104, v88, v89
    v_cvt_pk_bf16_f32 v105, v90, v91
    v_cvt_pk_bf16_f32 v106, v92, v93
    v_cvt_pk_bf16_f32 v107, v94, v95
    v_pk_mul_f32 v[88:89], v[8:9], s[44:45]
    v_pk_mul_f32 v[90:91], v[10:11], s[44:45]
    v_pk_mul_f32 v[92:93], v[12:13], s[44:45]
    v_pk_mul_f32 v[94:95], v[14:15], s[44:45]
    v_min_f32 v88, s35, v88
    v_min_f32 v89, s35, v89
    v_min_f32 v90, s35, v90
    v_min_f32 v91, s35, v91
    v_min_f32 v92, s35, v92
    v_min_f32 v93, s35, v93
    v_min_f32 v94, s35, v94
    v_min_f32 v95, s35, v95
    v_exp_f32 v88, v88
    v_exp_f32 v89, v89
    v_exp_f32 v90, v90
    v_exp_f32 v91, v91
    v_exp_f32 v92, v92
    v_exp_f32 v93, v93
    v_exp_f32 v94, v94
    v_exp_f32 v95, v95
    v_pk_add_f32 v[96:97], v[88:89], s[46:47]
    v_pk_add_f32 v[98:99], v[90:91], s[46:47]
    v_pk_add_f32 v[100:101], v[92:93], s[46:47]
    v_pk_add_f32 v[102:103], v[94:95], s[46:47]
    v_pk_mul_f32 v[88:89], v[88:89], v[96:97]
    v_pk_mul_f32 v[90:91], v[90:91], v[98:99]
    v_pk_mul_f32 v[92:93], v[92:93], v[100:101]
    v_pk_mul_f32 v[94:95], v[94:95], v[102:103]
    v_pk_add_f32 v[96:97], v[88:89], s[46:47]
    v_pk_add_f32 v[98:99], v[90:91], s[46:47]
    v_pk_add_f32 v[100:101], v[92:93], s[46:47]
    v_pk_add_f32 v[102:103], v[94:95], s[46:47]
    v_rcp_f32 v96, v96
    v_rcp_f32 v97, v97
    v_rcp_f32 v98, v98
    v_rcp_f32 v99, v99
    v_rcp_f32 v100, v100
    v_rcp_f32 v101, v101
    v_rcp_f32 v102, v102
    v_rcp_f32 v103, v103
    v_pk_mul_f32 v[88:89], v[88:89], v[8:9]
    v_pk_mul_f32 v[90:91], v[90:91], v[10:11]
    v_pk_mul_f32 v[92:93], v[92:93], v[12:13]
    v_pk_mul_f32 v[94:95], v[94:95], v[14:15]
    v_pk_mul_f32 v[88:89], v[88:89], v[96:97]
    v_pk_mul_f32 v[90:91], v[90:91], v[98:99]
    v_pk_mul_f32 v[92:93], v[92:93], v[100:101]
    v_pk_mul_f32 v[94:95], v[94:95], v[102:103]
    v_cvt_pk_bf16_f32 v108, v88, v89
    v_cvt_pk_bf16_f32 v109, v90, v91
    v_cvt_pk_bf16_f32 v110, v92, v93
    v_cvt_pk_bf16_f32 v111, v94, v95
    buffer_store_dwordx4 v[104:107], v167, s[4:7], s21 offen offset:0 sc1
    buffer_store_dwordx4 v[108:111], v167, s[4:7], s21 offen offset:256 sc1
L_attn:
    v_add_u32 v144, 0, v163
    v_lshrrev_b32 v145, 1, v163
    v_add_u32 v145, 8192, v145
    v_mov_b32 v110, 0
    v_mov_b32 v111, 0
    v_mov_b32 v112, 0
    v_mov_b32 v113, 0
    v_mov_b32 v64, 0
    v_mov_b32 v65, 0
    v_mov_b32 v66, 0
    v_mov_b32 v67, 0
    v_mov_b32 v68, 0
    v_mov_b32 v69, 0
    v_mov_b32 v70, 0
    v_mov_b32 v71, 0
    v_mov_b32 v72, 0
    v_mov_b32 v73, 0
    v_mov_b32 v74, 0
    v_mov_b32 v75, 0
    v_mov_b32 v76, 0
    v_mov_b32 v77, 0
    v_mov_b32 v78, 0
    v_mov_b32 v79, 0
    v_mov_b32 v80, 0
    v_mov_b32 v81, 0
    v_mov_b32 v82, 0
    v_mov_b32 v83, 0
    v_mov_b32 v84, 0
    v_mov_b32 v85, 0
    v_mov_b32 v86, 0
    v_mov_b32 v87, 0
    v_mov_b32 v88, 0
    v_mov_b32 v89, 0
    v_mov_b32 v90, 0
    v_mov_b32 v91, 0
    v_mov_b32 v92, 0
    v_mov_b32 v93, 0
    v_mov_b32 v94, 0
    v_mov_b32 v95, 0
    v_mov_b32 v118, 0
    v_mov_b32 v119, 0
    v_mov_b32 v120, 0
    v_mov_b32 v121, 0
    v_add_u32 v136, 0, v139
    s_mov_b32 s18, 0
    v_add_u32 v138, 0, v141
    v_mad_u32_u24 v137, v142, s18, v140
    s_mov_b32 s20, 0
    s_barrier
    ds_read_b128 v[102:105], v148
    ds_read_b128 v[106:109], v150
    ds_read_b128 v[122:125], v144
    ds_read_b64 v[126:127], v145
    s_mov_b32 exec_hi, 0
    ds_read_b64 v[110:111], v149
    ds_read_b64 v[112:113], v165
    s_mov_b64 exec, -1
    ds_read_b128 v[96:99], v136 offset:0
    ds_read_b64 v[100:101], v137 offset:0
    s_mul_i32 s24, s14, 3328
    s_xor_b32 s25, s14, 4
    s_mul_i32 s25, s25, 3328
    v_add_u32 v165, s24, v163
    v_add_u32 v166, s25, v163
    s_waitcnt lgkmcnt(2)
    v_mfma_f32_32x32x16_bf16 v[0:15], v[122:125], v[102:105], 0
    v_mfma_f32_32x32x8_bf16 v[0:15], v[126:127], v[110:111], v[0:15]
    v_mfma_f32_32x32x16_bf16 v[16:31], v[122:125], v[106:109], 0
    v_mfma_f32_32x32x8_bf16 v[16:31], v[126:127], v[112:113], v[16:31]
    s_nop 9
    v_max3_f32 v143, v0, v1, v2
    v_max3_f32 v143, v143, v3, v4
    v_max3_f32 v143, v143, v5, v6
    v_max3_f32 v143, v143, v7, v8
    v_max3_f32 v143, v143, v9, v10
    v_max3_f32 v143, v143, v11, v12
    v_max3_f32 v143, v143, v13, v14
    v_max_f32 v146, v143, v15
    v_max3_f32 v143, v16, v17, v18
    v_max3_f32 v143, v143, v19, v20
    v_max3_f32 v143, v143, v21, v22
    v_max3_f32 v143, v143, v23, v24
    v_max3_f32 v143, v143, v25, v26
    v_max3_f32 v143, v143, v27, v28
    v_max3_f32 v143, v143, v29, v30
    v_max_f32 v147, v143, v31
    v_mov_b32 v143, v146
    v_mov_b32 v144, v147
    s_nop 0
    v_permlane32_swap_b32 v143, v146
    v_permlane32_swap_b32 v144, v147
    s_nop 0
    v_max_f32 v146, v143, v146
    v_max_f32 v147, v144, v147
    s_mov_b32 exec_lo, 0
    v_sub_f32 v143, 0, v146
    v_and_b32 v144, 0xffff0000, v143
    v_sub_f32 v143, v143, v144
    v_and_b32 v145, 0xffff0000, v143
    v_sub_f32 v143, v143, v145
    v_lshrrev_b32 v144, 16, v144
    v_or_b32 v110, v144, v145
    v_lshrrev_b32 v111, 16, v143
    v_sub_f32 v143, 0, v147
    v_and_b32 v144, 0xffff0000, v143
    v_sub_f32 v143, v143, v144
    v_and_b32 v145, 0xffff0000, v143
    v_sub_f32 v143, v143, v145
    v_lshrrev_b32 v144, 16, v144
    v_or_b32 v112, v144, v145
    v_lshrrev_b32 v113, 16, v143
    s_mov_b64 exec, -1
    s_branch L_havem
L_restart:
    v_mov_b32 v64, 0
    v_mov_b32 v65, 0
    v_mov_b32 v66, 0
    v_mov_b32 v67, 0
    v_mov_b32 v68, 0
    v_mov_b32 v69, 0
    v_mov_b32 v70, 0
    v_mov_b32 v71, 0
    v_mov_b32 v72, 0
    v_mov_b32 v73, 0
    v_mov_b32 v74, 0
    v_mov_b32 v75, 0
    v_mov_b32 v76, 0
    v_mov_b32 v77, 0
    v_mov_b32 v78, 0
    v_mov_b32 v79, 0
    v_mov_b32 v80, 0
    v_mov_b32 v81, 0
    v_mov_b32 v82, 0
    v_mov_b32 v83, 0
    v_mov_b32 v84, 0
    v_mov_b32 v85, 0
    v_mov_b32 v86, 0
    v_mov_b32 v87, 0
    v_mov_b32 v88, 0
    v_mov_b32 v89, 0
    v_mov_b32 v90, 0
    v_mov_b32 v91, 0
    v_mov_b32 v92, 0
    v_mov_b32 v93, 0
    v_mov_b32 v94, 0
    v_mov_b32 v95, 0
    v_mov_b32 v118, 0
    v_mov_b32 v119, 0
    v_mov_b32 v120, 0
    v_mov_b32 v121, 0
    v_add_u32 v136, 0, v139
    s_mov_b32 s18, 0
    v_add_u32 v138, 0, v141
    v_mad_u32_u24 v137, v142, s18, v140
    s_barrier
    ds_read_b128 v[96:99], v136 offset:0
    ds_read_b64 v[100:101], v137 offset:0
L_havem:
    v_mov_b32 v126, 0
    v_mov_b32 v127, 0
    v_mov_b32 v128, 0
    v_mov_b32 v129, 0
    s_waitcnt lgkmcnt(0)
    v_mfma_f32_32x32x16_bf16 v[0:15], v[96:99], v[102:105], 0
    v_mfma_f32_32x32x16_bf16 v[16:31], v[96:99], v[106:109], 0
    ds_read_b128 v[96:99], v136 offset:1024
    ds_read_b64_tr_b16 v[114:115], v138 offset:0
    ds_read_b64_tr_b16 v[116:117], v138 offset:384
    v_mfma_f32_32x32x8_bf16 v[0:15], v[100:101], v[110:111], v[0:15]
    v_mfma_f32_32x32x8_bf16 v[16:31], v[100:101], v[112:113], v[16:31]
    ds_read_b64 v[100:101], v137 offset:256
    s_mov_b32 s18, 32768
    s_mov_b32 s19, 8
    s_nop 7
    s_branch L_mid
L_loop:
    s_waitcnt vmcnt(0)
    s_barrier
    v_add_u32 v136, s18, v139
    v_mad_u32_u24 v137, v142, s18, v140
    s_setprio 3
    s_waitcnt lgkmcnt(1)
    v_mfma_f32_32x32x16_bf16 v[32:47], v[96:99], v[102:105], 0
    v_exp_f32 v0, v0
    v_exp_f32 v1, v1
    v_exp_f32 v2, v2
    v_mfma_f32_32x32x16_bf16 v[80:95], v[118:121], v[126:129], v[80:95]
    ds_read_b64_tr_b16 v[118:119], v138 offset:3840
    ds_read_b64_tr_b16 v[120:121], v138 offset:4224
    v_exp_f32 v3, v3
    v_exp_f32 v4, v4
    v_exp_f32 v5, v5
    v_exp_f32 v6, v6
    v_exp_f32 v7, v7
    v_cvt_pk_bf16_f32 v122, v0, v1
    v_cvt_pk_bf16_f32 v123, v2, v3
    v_cvt_pk_bf16_f32 v124, v4, v5
    v_cvt_pk_bf16_f32 v125, v6, v7
    v_mfma_f32_32x32x16_bf16 v[48:63], v[96:99], v[106:109], 0
    ds_read_b128 v[96:99], v136 offset:0
    v_exp_f32 v16, v16
    v_exp_f32 v17, v17
    v_exp_f32 v18, v18
    v_mfma_f32_32x32x16_bf16 v[64:79], v[114:117], v[122:125], v[64:79]
    v_exp_f32 v19, v19
    v_exp_f32 v20, v20
    v_exp_f32 v21, v21
    v_exp_f32 v22, v22
    v_exp_f32 v23, v23
    v_cvt_pk_bf16_f32 v126, v16, v17
    v_cvt_pk_bf16_f32 v127, v18, v19
    v_cvt_pk_bf16_f32 v128, v20, v21
    v_cvt_pk_bf16_f32 v129, v22, v23
    s_waitcnt lgkmcnt(1)
    v_mfma_f32_32x32x8_bf16 v[32:47], v[100:101], v[110:111], v[32:47]
    v_exp_f32 v8, v8
    v_exp_f32 v9, v9
    v_exp_f32 v10, v10
    v_mfma_f32_32x32x16_bf16 v[80:95], v[114:117], v[126:129], v[80:95]
    ds_read_b64_tr_b16 v[114:115], v138 offset:4608
    ds_read_b64_tr_b16 v[116:117], v138 offset:4992
    v_exp_f32 v11, v11
    v_exp_f32 v12, v12
    v_exp_f32 v13, v13
    v_exp_f32 v14, v14
    v_exp_f32 v15, v15
    v_cvt_pk_bf16_f32 v122, v8, v9
    v_cvt_pk_bf16_f32 v123, v10, v11
    v_cvt_pk_bf16_f32 v124, v12, v13
    v_cvt_pk_bf16_f32 v125, v14, v15
    v_mfma_f32_32x32x8_bf16 v[48:63], v[100:101], v[112:113], v[48:63]
    ds_read_b64 v[100:101], v137 offset:0
    v_exp_f32 v24, v24
    v_exp_f32 v25, v25
    v_exp_f32 v26, v26
    v_mfma_f32_32x32x16_bf16 v[64:79], v[118:121], v[122:125], v[64:79]
    v_exp_f32 v27, v27
    v_exp_f32 v28, v28
    v_exp_f32 v29, v29
    v_exp_f32 v30, v30
    v_exp_f32 v31, v31
    v_cvt_pk_bf16_f32 v126, v24, v25
    v_cvt_pk_bf16_f32 v127, v26, v27
    v_cvt_pk_bf16_f32 v128, v28, v29
    v_cvt_pk_bf16_f32 v129, v30, v31
    s_setprio 2
    s_waitcnt lgkmcnt(1)
    v_mfma_f32_32x32x16_bf16 v[0:15], v[96:99], v[102:105], 0
    v_exp_f32 v32, v32
    v_exp_f32 v33, v33
    v_exp_f32 v34, v34
    v_mfma_f32_32x32x16_bf16 v[80:95], v[118:121], v[126:129], v[80:95]
    ds_read_b64_tr_b16 v[118:119], v138 offset:5376
    ds_read_b64_tr_b16 v[120:121], v138 offset:5760
    v_add_u32 v138, s18, v141
    v_exp_f32 v35, v35
    v_exp_f32 v36, v36
    v_exp_f32 v37, v37
    v_exp_f32 v38, v38
    v_exp_f32 v39, v39
    v_cvt_pk_bf16_f32 v122, v32, v33
    v_cvt_pk_bf16_f32 v123, v34, v35
    v_cvt_pk_bf16_f32 v124, v36, v37
    v_cvt_pk_bf16_f32 v125, v38, v39
    v_mfma_f32_32x32x16_bf16 v[16:31], v[96:99], v[106:109], 0
    ds_read_b128 v[96:99], v136 offset:1024
    v_exp_f32 v48, v48
    v_exp_f32 v49, v49
    v_exp_f32 v50, v50
    v_mfma_f32_32x32x16_bf16 v[64:79], v[114:117], v[122:125], v[64:79]
    v_exp_f32 v51, v51
    v_exp_f32 v52, v52
    v_exp_f32 v53, v53
    v_exp_f32 v54, v54
    v_exp_f32 v55, v55
    v_cvt_pk_bf16_f32 v126, v48, v49
    v_cvt_pk_bf16_f32 v127, v50, v51
    v_cvt_pk_bf16_f32 v128, v52, v53
    v_cvt_pk_bf16_f32 v129, v54, v55
    s_waitcnt lgkmcnt(1)
    v_mfma_f32_32x32x8_bf16 v[0:15], v[100:101], v[110:111], v[0:15]
    v_exp_f32 v40, v40
    v_exp_f32 v41, v41
    v_exp_f32 v42, v42
    v_mfma_f32_32x32x16_bf16 v[80:95], v[114:117], v[126:129], v[80:95]
    ds_read_b64_tr_b16 v[114:115], v138 offset:0
    ds_read_b64_tr_b16 v[116:117], v138 offset:384
    v_exp_f32 v43, v43
    v_exp_f32 v44, v44
    v_exp_f32 v45, v45
    v_exp_f32 v46, v46
    v_exp_f32 v47, v47
    v_cvt_pk_bf16_f32 v122, v40, v41
    v_cvt_pk_bf16_f32 v123, v42, v43
    v_cvt_pk_bf16_f32 v124, v44, v45
    v_cvt_pk_bf16_f32 v125, v46, v47
    v_mfma_f32_32x32x8_bf16 v[16:31], v[100:101], v[112:113], v[16:31]
    ds_read_b64 v[100:101], v137 offset:256
    v_exp_f32 v56, v56
    v_exp_f32 v57, v57
    v_exp_f32 v58, v58
    v_mfma_f32_32x32x16_bf16 v[64:79], v[118:121], v[122:125], v[64:79]
    v_exp_f32 v59, v59
    v_exp_f32 v60, v60
    v_exp_f32 v61, v61
    v_exp_f32 v62, v62
    v_exp_f32 v63, v63
    v_cvt_pk_bf16_f32 v126, v56, v57
    v_cvt_pk_bf16_f32 v127, v58, v59
    v_cvt_pk_bf16_f32 v128, v60, v61
    v_cvt_pk_bf16_f32 v129, v62, v63
    s_cmp_eq_u32 s18, 32768
    s_cselect_b32 s24, 55296, 0
    s_cmp_eq_u32 s18, 0
    s_cselect_b32 s18, 32768, s24
    s_sub_u32 s19, s19, 1
    s_cmp_eq_u32 s19, 0
    s_cbranch_scc1 L_done
L_mid:
    s_setprio 1
    s_waitcnt lgkmcnt(1)
    v_mfma_f32_32x32x16_bf16 v[32:47], v[96:99], v[102:105], 0
    v_exp_f32 v0, v0
    v_exp_f32 v1, v1
    v_exp_f32 v2, v2
    v_mfma_f32_32x32x16_bf16 v[80:95], v[118:121], v[126:129], v[80:95]
    ds_read_b64_tr_b16 v[118:119], v138 offset:768
    ds_read_b64_tr_b16 v[120:121], v138 offset:1152
    v_exp_f32 v3, v3
    v_exp_f32 v4, v4
    v_exp_f32 v5, v5
    v_exp_f32 v6, v6
    v_exp_f32 v7, v7
    v_cvt_pk_bf16_f32 v122, v0, v1
    v_cvt_pk_bf16_f32 v123, v2, v3
    v_cvt_pk_bf16_f32 v124, v4, v5
    v_cvt_pk_bf16_f32 v125, v6, v7
    v_mfma_f32_32x32x16_bf16 v[48:63], v[96:99], v[106:109], 0
    ds_read_b128 v[96:99], v136 offset:2048
    v_exp_f32 v16, v16
    v_exp_f32 v17, v17
    v_exp_f32 v18, v18
    v_mfma_f32_32x32x16_bf16 v[64:79], v[114:117], v[122:125], v[64:79]
    v_exp_f32 v19, v19
    v_exp_f32 v20, v20
    v_exp_f32 v21, v21
    v_exp_f32 v22, v22
    v_exp_f32 v23, v23
    v_cvt_pk_bf16_f32 v126, v16, v17
    v_cvt_pk_bf16_f32 v127, v18, v19
    v_cvt_pk_bf16_f32 v128, v20, v21
    v_cvt_pk_bf16_f32 v129, v22, v23
    s_waitcnt lgkmcnt(1)
    v_mfma_f32_32x32x8_bf16 v[32:47], v[100:101], v[110:111], v[32:47]
    v_exp_f32 v8, v8
    v_exp_f32 v9, v9
    v_exp_f32 v10, v10
    v_mfma_f32_32x32x16_bf16 v[80:95], v[114:117], v[126:129], v[80:95]
    ds_read_b64_tr_b16 v[114:115], v138 offset:1536
    ds_read_b64_tr_b16 v[116:117], v138 offset:1920
    v_exp_f32 v11, v11
    v_exp_f32 v12, v12
    v_exp_f32 v13, v13
    v_exp_f32 v14, v14
    v_exp_f32 v15, v15
    v_cvt_pk_bf16_f32 v122, v8, v9
    v_cvt_pk_bf16_f32 v123, v10, v11
    v_cvt_pk_bf16_f32 v124, v12, v13
    v_cvt_pk_bf16_f32 v125, v14, v15
    v_mfma_f32_32x32x8_bf16 v[48:63], v[100:101], v[112:113], v[48:63]
    ds_read_b64 v[100:101], v137 offset:512
    v_exp_f32 v24, v24
    v_exp_f32 v25, v25
    v_exp_f32 v26, v26
    v_mfma_f32_32x32x16_bf16 v[64:79], v[118:121], v[122:125], v[64:79]
    v_exp_f32 v27, v27
    v_exp_f32 v28, v28
    v_exp_f32 v29, v29
    v_exp_f32 v30, v30
    v_exp_f32 v31, v31
    v_cvt_pk_bf16_f32 v126, v24, v25
    v_cvt_pk_bf16_f32 v127, v26, v27
    v_cvt_pk_bf16_f32 v128, v28, v29
    v_cvt_pk_bf16_f32 v129, v30, v31
    s_setprio 0
    s_waitcnt lgkmcnt(1)
    v_mfma_f32_32x32x16_bf16 v[0:15], v[96:99], v[102:105], 0
    v_exp_f32 v32, v32
    v_exp_f32 v33, v33
    v_exp_f32 v34, v34
    v_mfma_f32_32x32x16_bf16 v[80:95], v[118:121], v[126:129], v[80:95]
    ds_read_b64_tr_b16 v[118:119], v138 offset:2304
    ds_read_b64_tr_b16 v[120:121], v138 offset:2688
    v_exp_f32 v35, v35
    v_exp_f32 v36, v36
    v_exp_f32 v37, v37
    v_exp_f32 v38, v38
    v_exp_f32 v39, v39
    v_cvt_pk_bf16_f32 v122, v32, v33
    v_cvt_pk_bf16_f32 v123, v34, v35
    v_cvt_pk_bf16_f32 v124, v36, v37
    v_cvt_pk_bf16_f32 v125, v38, v39
    v_mfma_f32_32x32x16_bf16 v[16:31], v[96:99], v[106:109], 0
    ds_read_b128 v[96:99], v136 offset:3072
    v_exp_f32 v48, v48
    v_exp_f32 v49, v49
    v_exp_f32 v50, v50
    v_mfma_f32_32x32x16_bf16 v[64:79], v[114:117], v[122:125], v[64:79]
    v_exp_f32 v51, v51
    v_exp_f32 v52, v52
    v_exp_f32 v53, v53
    v_exp_f32 v54, v54
    v_exp_f32 v55, v55
    v_cvt_pk_bf16_f32 v126, v48, v49
    v_cvt_pk_bf16_f32 v127, v50, v51
    v_cvt_pk_bf16_f32 v128, v52, v53
    v_cvt_pk_bf16_f32 v129, v54, v55
    s_waitcnt lgkmcnt(1)
    v_mfma_f32_32x32x8_bf16 v[0:15], v[100:101], v[110:111], v[0:15]
    v_exp_f32 v40, v40
    v_exp_f32 v41, v41
    v_exp_f32 v42, v42
    v_mfma_f32_32x32x16_bf16 v[80:95], v[114:117], v[126:129], v[80:95]
    ds_read_b64_tr_b16 v[114:115], v138 offset:3072
    ds_read_b64_tr_b16 v[116:117], v138 offset:3456
    v_exp_f32 v43, v43
    v_exp_f32 v44, v44
    v_exp_f32 v45, v45
    v_exp_f32 v46, v46
    v_exp_f32 v47, v47
    v_cvt_pk_bf16_f32 v122, v40, v41
    v_cvt_pk_bf16_f32 v123, v42, v43
    v_cvt_pk_bf16_f32 v124, v44, v45
    v_cvt_pk_bf16_f32 v125, v46, v47
    v_mfma_f32_32x32x8_bf16 v[16:31], v[100:101], v[112:113], v[16:31]
    ds_read_b64 v[100:101], v137 offset:768
    v_exp_f32 v56, v56
    v_exp_f32 v57, v57
    v_exp_f32 v58, v58
    v_mfma_f32_32x32x16_bf16 v[64:79], v[118:121], v[122:125], v[64:79]
    v_exp_f32 v59, v59
    v_exp_f32 v60, v60
    v_exp_f32 v61, v61
    v_exp_f32 v62, v62
    v_exp_f32 v63, v63
    v_cvt_pk_bf16_f32 v126, v56, v57
    v_cvt_pk_bf16_f32 v127, v58, v59
    v_cvt_pk_bf16_f32 v128, v60, v61
    v_cvt_pk_bf16_f32 v129, v62, v63
    s_branch L_loop
L_done:
    v_mfma_f32_32x32x16_bf16 v[80:95], v[118:121], v[126:129], v[80:95]
    s_nop 11
    ds_write_b128 v165, v[80:83] offset:0
    ds_write_b128 v165, v[84:87] offset:1024
    ds_write_b128 v165, v[88:91] offset:2048
    v_lshrrev_b32 v143, 2, v163
    v_sub_u32 v144, v165, v163
    v_add_u32 v144, v144, v143
    v_sub_u32 v145, v166, v163
    v_add_u32 v145, v145, v143
    ds_write_b32 v144, v92 offset:3072
    s_waitcnt lgkmcnt(0)
    s_barrier
    ds_read_b128 v[32:35], v166 offset:0
    ds_read_b128 v[36:39], v166 offset:1024
    ds_read_b128 v[40:43], v166 offset:2048
    ds_read_b32 v44, v145 offset:3072
    s_mov_b32 s24, 0x7b800000
    s_waitcnt lgkmcnt(0)
    v_add_f32 v76, v76, v44
    v_pk_add_f32 v[64:65], v[64:65], v[32:33]
    v_pk_add_f32 v[66:67], v[66:67], v[34:35]
    v_pk_add_f32 v[68:69], v[68:69], v[36:37]
    v_pk_add_f32 v[70:71], v[70:71], v[38:39]
    v_pk_add_f32 v[72:73], v[72:73], v[40:41]
    v_pk_add_f32 v[74:75], v[74:75], v[42:43]
    v_rcp_f32 v144, v76
    v_pk_add_f32 v[32:33], v[64:65], v[70:71]
    v_pk_add_f32 v[34:35], v[66:67], v[72:73]
    v_pk_add_f32 v[36:37], v[68:69], v[74:75]
    v_mov_b32 v145, v144
    v_pk_add_f32 v[32:33], v[32:33], v[34:35]
    v_pk_add_f32 v[32:33], v[32:33], v[36:37]
    v_pk_mul_f32 v[64:65], v[64:65], v[144:145]
    v_pk_mul_f32 v[66:67], v[66:67], v[144:145]
    v_pk_mul_f32 v[68:69], v[68:69], v[144:145]
    v_pk_mul_f32 v[70:71], v[70:71], v[144:145]
    v_pk_mul_f32 v[72:73], v[72:73], v[144:145]
    v_pk_mul_f32 v[74:75], v[74:75], v[144:145]
    v_add_f32 v32, v32, v33
    v_fma_f32 v144, v32, 0, v76
    v_cmp_gt_f32 vcc, s24, v144
    v_cvt_pk_bf16_f32 v0, v64, v65
    v_cvt_pk_bf16_f32 v1, v66, v67
    v_cvt_pk_bf16_f32 v2, v68, v69
    v_cvt_pk_bf16_f32 v3, v70, v71
    v_cvt_pk_bf16_f32 v4, v72, v73
    v_cvt_pk_bf16_f32 v5, v74, v75
    v_mov_b32 v147, 159744
    s_cmp_lg_u32 s20, 0
    s_cbranch_scc1 L_store
    s_cmp_eq_u64 vcc, -1
    s_cbranch_scc1 L_store
    v_mov_b32 v148, 1
    ds_write_b32 v147, v148
    s_branch L_vote
L_store:
    buffer_store_dwordx4 v[0:3], v151, s[4:7], 0 offen sc1
    s_mov_b32 exec_hi, 0
    buffer_store_dwordx2 v[4:5], v152, s[4:7], 0 offen sc1
    s_mov_b64 exec, -1
L_vote:
    s_waitcnt lgkmcnt(0)
    s_barrier
    s_cmp_lg_u32 s20, 0
    s_cbranch_scc1 L_end
    ds_read_b32 v148, v147
    s_waitcnt lgkmcnt(0)
    v_readfirstlane_b32 s24, v148
    s_nop 1
    s_cmp_eq_u32 s24, 0
    s_cbranch_scc1 L_end
    s_mov_b32 s20, 1
    s_mov_b32 s19, 8
    v_mov_b32 v146, 0xff800000
    v_mov_b32 v147, 0xff800000
    v_add_u32 v136, 32768, v163
    v_lshrrev_b32 v137, 1, v163
    v_add_u32 v137, 40960, v137
    s_mov_b32 exec_lo, 0
    v_mov_b32 v110, 0
    v_mov_b32 v111, 0
    v_mov_b32 v112, 0
    v_mov_b32 v113, 0
    s_mov_b64 exec, -1
L_maxloop:
    s_barrier
    s_barrier
    s_mov_b32 s24, 8
L_maxblk:
    ds_read_b128 v[96:99], v136 offset:0
    ds_read_b64 v[100:101], v137 offset:0
    v_add_u32 v136, 1024, v136
    v_add_u32 v137, 256, v137
    s_waitcnt lgkmcnt(0)
    v_mfma_f32_32x32x16_bf16 v[0:15], v[96:99], v[102:105], 0
    v_mfma_f32_32x32x16_bf16 v[16:31], v[96:99], v[106:109], 0
    v_mfma_f32_32x32x8_bf16 v[0:15], v[100:101], v[110:111], v[0:15]
    v_mfma_f32_32x32x8_bf16 v[16:31], v[100:101], v[112:113], v[16:31]
    s_nop 11
    v_max3_f32 v143, v0, v1, v2
    v_max3_f32 v143, v143, v3, v4
    v_max3_f32 v143, v143, v5, v6
    v_max3_f32 v143, v143, v7, v8
    v_max3_f32 v143, v143, v9, v10
    v_max3_f32 v143, v143, v11, v12
    v_max3_f32 v143, v143, v13, v14
    v_max3_f32 v146, v143, v15, v146
    v_max3_f32 v143, v16, v17, v18
    v_max3_f32 v143, v143, v19, v20
    v_max3_f32 v143, v143, v21, v22
    v_max3_f32 v143, v143, v23, v24
    v_max3_f32 v143, v143, v25, v26
    v_max3_f32 v143, v143, v27, v28
    v_max3_f32 v143, v143, v29, v30
    v_max3_f32 v147, v143, v31, v147
    s_sub_u32 s24, s24, 1
    s_cmp_lg_u32 s24, 0
    s_cbranch_scc1 L_maxblk
    v_subrev_u32 v136, 8192, v136
    v_subrev_u32 v137, 2048, v137
    s_sub_u32 s19, s19, 1
    s_cmp_lg_u32 s19, 0
    s_cbranch_scc1 L_maxloop
    v_mov_b32 v143, v146
    v_mov_b32 v144, v147
    s_nop 0
    v_permlane32_swap_b32 v143, v146
    v_permlane32_swap_b32 v144, v147
    s_nop 0
    v_max_f32 v146, v143, v146
    v_max_f32 v147, v144, v147
    s_mov_b32 exec_lo, 0
    v_sub_f32 v143, 0, v146
    v_and_b32 v144, 0xffff0000, v143
    v_sub_f32 v143, v143, v144
    v_and_b32 v145, 0xffff0000, v143
    v_sub_f32 v143, v143, v145
    v_lshrrev_b32 v144, 16, v144
    v_or_b32 v110, v144, v145
    v_lshrrev_b32 v111, 16, v143
    v_sub_f32 v143, 0, v147
    v_and_b32 v144, 0xffff0000, v143
    v_sub_f32 v143, v143, v144
    v_and_b32 v145, 0xffff0000, v143
    v_sub_f32 v143, v143, v145
    v_lshrrev_b32 v144, 16, v144
    v_or_b32 v112, v144, v145
    v_lshrrev_b32 v113, 16, v143
    s_mov_b64 exec, -1
    s_barrier
    s_branch L_restart
L_end:
L_exit:
    s_endpgm
.section .rodata,"a"
.p2align 6
.amdhsa_kernel gated_mix__mha_block__dense_activation_mish__prompt_kernel
  .amdhsa_next_free_vgpr 168
  .amdhsa_next_free_sgpr 102
  .amdhsa_accum_offset 168
  .amdhsa_group_segment_fixed_size 0
  .amdhsa_kernarg_size 88
  .amdhsa_user_sgpr_count 2
  .amdhsa_user_sgpr_kernarg_segment_ptr 1
  .amdhsa_system_sgpr_workgroup_id_x 1
.end_amdhsa_kernel
```
